```python
import torch

def _softmax(x, axis=-1):
    return torch.softmax(x, dim=axis)
def _gelu(x):
    return torch.nn.functional.gelu(x, approximate="tanh")
def _silu(x):
    return torch.nn.functional.silu(x)
def _sigmoid(x):
    return torch.sigmoid(x)
def _layernorm(x, axis=-1, eps=1e-5):
    m = x.mean(dim=axis, keepdim=True)
    v = x.var(dim=axis, keepdim=True, unbiased=False)
    return (x - m) / torch.sqrt(v + eps)
def _scatter_add(tgt, idx, src, axis=0):
    return tgt.clone().index_add_(axis, idx, src)
def _segment_sum(src, seg, n):
    out = torch.zeros((n,) + src.shape[1:], dtype=src.dtype)
    return out.index_add_(0, seg, src)
def _pad(x, pw):
    flat = tuple(v for pair in reversed(pw) for v in pair)
    return torch.nn.functional.pad(x, flat)

kernel_name = 'gated_mix__linear_attn_block__ssm_conv_h3__prompt'

def setup_inputs():

    _w = (lambda a: (lambda t: t.to(torch.bfloat16) if t.is_floating_point() else t)(torch.as_tensor(a)))
    def _A_setup():
        B, S, D = 1, 2048, 640
        return {
            "x": _w((lambda *s: torch.randn(*s, dtype=torch.bfloat16) * 0.05)(B, S, D)),
            "wqkv": _w((lambda *s: torch.randn(*s, dtype=torch.bfloat16) * 1.6)(D, 3 * D)),
            "wo": _w((lambda *s: torch.randn(*s, dtype=torch.bfloat16) * 0.1)(D, D)),
        }
    _A_in = _A_setup()

    def _B_setup():
        B, S, D = 1, 2048, 640
        ks = 4
        return {
            "q": _w((lambda *s: torch.randn(*s, dtype=torch.bfloat16) * 0.05)(B, S, D)),
            "k": _w((lambda *s: torch.randn(*s, dtype=torch.bfloat16) * 0.8)(B, S, D)),
            "v": _w((lambda *s: torch.randn(*s, dtype=torch.bfloat16) * 0.8)(B, S, D)),
            "shift_k": _w((lambda *s: torch.randn(*s, dtype=torch.bfloat16) * 0.8)(D, ks) * 0.5),
            "ssm_k": _w((lambda *s: torch.randn(*s, dtype=torch.bfloat16) * 0.8)(D, S) * (1.0 / S ** 0.5)),
            "ssm_D": _w((lambda *s: torch.randn(*s, dtype=torch.bfloat16) * 0.8)(D)),
        }
    _B_in = _B_setup()

    return {
        "A_x": _A_in["x"],
        "A_wqkv": _A_in["wqkv"],
        "A_wo": _A_in["wo"],
        "B_q": _B_in["q"],
        "B_k": _B_in["k"],
        "B_v": _B_in["v"],
        "B_shift_k": _B_in["shift_k"],
        "B_ssm_k": _B_in["ssm_k"],
        "B_ssm_D": _B_in["ssm_D"],
        "gate_w": _w((lambda *s: torch.randn(*s, dtype=torch.bfloat16) * 0.05)(640) * 16.0),
    }

def reference(A_x, A_wqkv, A_wo, B_q, B_k, B_v, B_shift_k, B_ssm_k, B_ssm_D, gate_w):
    def _A_ref(x, wqkv, wo):
        B, S, D = x.shape
        H = 32; Dh = D // H
        qkv = (lambda x, *d: x.permute(*d))((x @ wqkv).reshape(B, S, 3, H, Dh), 2, 0, 3, 1, 4)
        q, k, v = qkv[0], qkv[1], qkv[2]
        phi = lambda t: torch.where(t > 0, t + 1, torch.exp(t)) + 1e-6
        pq, pk = phi(q), phi(k)
        kv = torch.einsum("bhsd,bhse->bhde", pk, v)
        z = torch.einsum("bhsd->bhd", pk)
        num = torch.einsum("bhqd,bhde->bhqe", pq, kv)
        den = torch.einsum("bhqd,bhd->bhq", pq, z)[..., None] + 1e-6
        o = num / den
        return (lambda x, *d: x.permute(*d))(o, 0, 2, 1, 3).reshape(B, S, D) @ wo

    def _B_ref(q, k, v, shift_k, ssm_k, ssm_D):
        B, S, D = q.shape
        ks = shift_k.shape[-1]
        k_pad = _pad(k, ((0, 0), (ks - 1, 0), (0, 0)))
        k_shift = torch.zeros_like(k)
        for t in range(ks):
            k_shift = k_shift + k_pad[:, t:t + S, :] * shift_k[:, ks - 1 - t][None, None, :]
        kv = k_shift * v
        L = 2 * S
        kv_pad = _pad(kv, ((0, 0), (0, S), (0, 0)))
        kf_pad = _pad(ssm_k, ((0, 0), (0, S)))
        kv_f = (lambda x, axes=(-2,-1): torch.fft.rfft2(x.float(), dim=axes))(kv_pad[:, None, :, :], axes=(1, 2))
        kf_f = (lambda x, axes=(-2,-1): torch.fft.rfft2(x.float(), dim=axes))(kf_pad[:, None, :], axes=(1, 2))
        kf_f = (lambda x, *d: x.permute(*d))(kf_f, 1, 2, 0)
        y_f = kv_f * kf_f[None, :, :, :]
        y = (lambda x, s, axes=(-2,-1): torch.fft.irfft2(x, s=s, dim=axes).to(torch.bfloat16))(y_f, (1, L), axes=(1, 2))[:, 0, :S, :]
        y = y + kv * ssm_D[None, None, :]
        return q * y

    x = A_x
    g = _sigmoid((x * gate_w).sum(-1, keepdims=True))
    a = _A_ref(x, A_wqkv, A_wo)
    b = _B_ref(x, B_k, B_v, B_shift_k, B_ssm_k, B_ssm_D)
    return g * a + (1 - g) * b
```

```asm
; @launch grid=(256,1,1) block=(512,1,1) lds=158464
.amdgcn_target "amdgcn-amd-amdhsa--gfx950"
.text
.globl gated_mix__linear_attn_block__ssm_conv_h3__prompt_kernel
.p2align 8
.type gated_mix__linear_attn_block__ssm_conv_h3__prompt_kernel,@function
gated_mix__linear_attn_block__ssm_conv_h3__prompt_kernel:
Lentry:
    s_cmp_ge_u32 s2, 256
    s_cbranch_scc1 Lend
    s_getpc_b64 s[66:67]
Lpcref:
    s_lshr_b32 s52, s2, 3
    s_mul_i32 s68, s52, 9
    v_min_u32 v1, 8, v0
    v_add_lshl_u32 v1, v1, s68, 7
    v_min_u32 v1, Lend-Lpcref, v1
    global_load_dword v255, v1, s[66:67]
    s_load_dwordx2 s[4:5], s[0:1], 0
    s_load_dwordx2 s[8:9], s[0:1], 8
    s_load_dwordx2 s[16:17], s[0:1], 32
    s_load_dwordx2 s[20:21], s[0:1], 40
    s_load_dwordx2 s[24:25], s[0:1], 48
    s_load_dwordx2 s[44:45], s[0:1], 96
    s_load_dwordx2 s[40:41], s[0:1], 88
    s_load_dwordx2 s[28:29], s[0:1], 56
    s_load_dwordx2 s[12:13], s[0:1], 16
    s_load_dwordx2 s[32:33], s[0:1], 72
    s_load_dwordx2 s[36:37], s[0:1], 80
    s_load_dwordx2 s[48:49], s[0:1], 64
    v_lshrrev_b32 v1, 6, v0
    v_and_b32 v0, 63, v0
    v_readfirstlane_b32 s50, v1
    s_bitcmp1_b32 s2, 2
    s_cselect_b32 s51, 24, 24
    s_and_b32 s53, s2, 3
    s_bfe_u32 s54, s2, 0x10002
    s_mov_b32 s78, s2
    s_mov_b32 s55, 1
    s_and_b32 s66, s52, 3
    s_lshl_b32 s57, s53, 2
    s_add_u32 s57, s57, s66
    s_cmp_ge_u32 s52, s51
    s_cbranch_scc1 Lctype
    s_cmp_lt_u32 s50, 4
    s_cbranch_scc1 Lawave
    s_sub_u32 s64, s50, 4
    v_lshrrev_b32 v1, 3, v0
    v_mul_u32_u24 v1, 1280, v1
    v_lshrrev_b32 v2, 4, v0
    v_and_b32 v3, 7, v0
    v_xor_b32 v2, v2, v3
    v_lshl_add_u32 v32, v2, 4, v1
    v_xor_b32 v33, 64, v32
    v_add_u32 v33, 9216, v33
    v_add_u32 v34, 18432, v32
    v_add_u32 v35, 18432, v33
    s_lshl_b32 s58, s57, 2
    s_add_u32 s58, s58, s64
    s_mul_i32 s58, s58, 40960
    s_lshr_b32 s66, s52, 2
    s_add_u32 s76, s66, s52
    s_and_b32 s76, s76, 3
    s_add_u32 s99, s53, s54
    s_and_b32 s99, s99, 1
    s_lshl_b32 s99, s99, 2
    s_or_b32 s76, s76, s99
    s_bitcmp1_b32 s76, 2
    s_cselect_b32 s74, 1, 3
    s_cselect_b32 s75, 8, 0
    s_and_b32 s74, s74, s76
    s_xor_b32 s74, s74, s75
    s_lshl_b32 s99, s64, 12
    s_mov_b32 s6, 2621440
    s_mov_b32 s7, 0x20000
    s_mov_b32 s10, 2457600
    s_mov_b32 s11, 0x20000
    s_lshl_b32 s67, s54, 2
    s_add_u32 s67, s67, s66
    s_add_u32 s67, s67, 8
    s_lshl_b32 s66, s66, 1
    s_mul_i32 s70, s54, 4
    s_add_u32 s66, s66, s70
    s_sub_u32 s66, s66, 8
    s_cmp_ge_u32 s52, 16
    s_cselect_b32 s65, s66, s67
    s_cselect_b32 s70, 10, 5
    s_cselect_b32 s71, 4, 0x50
    s_cselect_b32 s72, 1, 3
    s_cselect_b32 s73, 2, 1
    s_cselect_b32 s66, 1, 0x50
    s_cselect_b32 s67, 8, 2
    s_mulk_i32 s65, 160
    s_mul_i32 s68, s64, 61440
    s_add_u32 s65, s65, s68
    s_lshl_b32 s57, s64, 10
    s_add_u32 s57, s57, 32768
    v_lshrrev_b32 v14, 4, v0
    v_lshrrev_b32 v15, 1, v0
    v_xor_b32 v15, v15, v14
    v_and_b32 v16, 1, v0
    v_mul_u32_u24 v14, 240, v14
    v_mad_u32_u24 v14, v16, s73, v14
    v_and_b32 v17, 1, v15
    v_mad_u32_u24 v14, v17, s72, v14
    v_bfe_u32 v17, v15, 1, 1
    v_mad_u32_u24 v14, v17, s71, v14
    v_bfe_u32 v17, v15, 2, 1
    v_mad_u32_u24 v18, v17, s70, v14
    v_lshlrev_b32 v36, 4, v18
    v_add_u32 v37, 14336, v36
    v_xor_b32 v17, 1, v17
    v_mad_u32_u24 v18, v17, s70, v14
    v_lshlrev_b32 v18, 4, v18
    v_add_u32 v38, 28672, v18
    v_add_u32 v39, 43008, v18
    v_lshrrev_b32 v14, 2, v0
    v_mul_u32_u24 v14, 240, v14
    v_mad_u32_u24 v14, v16, s66, v14
    v_lshrrev_b32 v17, 4, v0
    v_xor_b32 v17, v17, v0
    v_bfe_u32 v17, v17, 1, 1
    v_mad_u32_u24 v14, v17, s70, v14
    v_add_lshl_u32 v40, v14, s67, 4
    s_waitcnt lgkmcnt(0)
    s_mov_b32 m0, s99
    s_lshl_b32 s75, s74, 7
    s_add_u32 s75, s75, s58
    buffer_load_dwordx4 v32, s[4:7], s75 offen offset:0 lds
    buffer_load_dwordx4 v33, s[4:7], s75 offen offset:1024 lds
    buffer_load_dwordx4 v34, s[4:7], s75 offen offset:2048 lds
    buffer_load_dwordx4 v35, s[4:7], s75 offen offset:3072 lds
    s_add_u32 m0, s99, 16384
    s_mul_i32 s79, s74, 245760
    s_add_u32 s79, s79, s65
    buffer_load_dwordx4 v36, s[8:11], s79 offen offset:0 lds
    buffer_load_dwordx4 v37, s[8:11], s79 offen offset:1024 lds
    s_add_u32 m0, s57, 0
    s_nop 0
    buffer_load_dwordx4 v40, s[8:11], s79 offen offset:0 lds
    s_add_u32 m0, s99, 16384
    s_nop 0
    buffer_load_dwordx4 v38, s[8:11], s79 offen offset:2048 lds
    buffer_load_dwordx4 v39, s[8:11], s79 offen offset:3072 lds
    s_waitcnt lgkmcnt(0)
    s_bfe_u32 s66, s52, 0x20002
    s_mul_i32 s67, s54, 2
    s_add_u32 s66, s66, s67
    s_lshl_b32 s66, s66, 2
    s_add_u32 s66, s66, s64
    s_and_b32 s68, s52, 3
    s_lshl_b32 s69, s53, 2
    s_add_u32 s68, s68, s69
    s_lshl_b32 s0, s68, 4
    s_add_u32 s0, s0, s66
    s_cmp_ge_u32 s52, 16
    s_cselect_b32 s1, 1, 0
    s_lshl_b32 s66, s66, 10
    v_lshlrev_b32 v41, 4, v0
    s_mov_b32 s34, 1280
    s_mov_b32 s35, 0x20000
    s_mov_b32 m0, 156416
    v_add_u32 v42, s66, v41
    v_add_u32 v55, 73728, v42
    s_cmp_ge_u32 s52, 16
    s_cbranch_scc0 Lbng
    buffer_load_dwordx4 v41, s[32:35], 0 offen lds
    buffer_load_dwordx4 v41, s[32:35], 0 offen offset:1024 lds
Lbng:
    s_and_b32 s67, s64, 1
    s_lshl_b32 s67, s67, 2
    v_xor_b32 v43, s67, v2
    v_lshlrev_b32 v43, 4, v43
    v_add_u32 v43, 156416, v43
    v_mov_b32 v52, 0
    v_mov_b32 v53, 0
    s_mov_b32 s6, 2621440
    s_mov_b32 s7, 0x20000
    s_mov_b32 s30, 2621440
    s_mov_b32 s31, 0x20000
    s_mov_b32 s46, 9437184
    s_mov_b32 s47, 0x20000
    s_mov_b32 s42, 256
    s_mov_b32 s43, 0x20000
    s_mov_b32 s38, 2621440
    s_mov_b32 s39, 0x20000
    s_mul_i32 s73, s53, 48
    s_mul_i32 s67, s54, 24
    s_add_u32 s73, s73, s67
    s_add_u32 s73, s73, s52
    s_lshr_b32 s59, s73, 1
    s_add_u32 s59, s59, 64
    s_and_b32 s67, s52, 1
    s_lshl_b32 s67, s67, 1
    s_waitcnt lgkmcnt(0)
    s_lshr_b32 s61, s64, 1
    s_and_b32 s62, s64, 1
    s_add_u32 s60, s67, s61
    s_lshl_b32 s63, s59, 2
    s_add_u32 s63, s63, s60
    s_lshl_b32 s70, s63, 1
    s_and_b32 s70, s70, -4
    s_load_dword s77, s[48:49], s70
    v_and_b32 v96, 31, v0
    v_lshrrev_b32 v97, 5, v0
    v_lshl_add_u32 v98, v97, 2, v96
    v_lshrrev_b32 v99, 2, v98
    v_add_u32 v99, 3, v99
    v_and_b32 v99, 3, v99
    v_xor_b32 v99, s60, v99
    v_lshlrev_b32 v99, 4, v99
    v_lshl_add_u32 v99, v98, 6, v99
    v_add_u32 v148, 110848, v99
    v_xor_b32 v149, 32, v148
    v_bfe_u32 v98, v0, 4, 1
    v_and_b32 v99, 3, v0
    v_lshl_add_u32 v98, v98, 2, v99
    v_bfe_u32 v96, v0, 2, 2
    v_sub_u32 v98, v98, v96
    v_lshlrev_b32 v97, 3, v97
    v_sub_u32 v98, v98, v97
    v_lshlrev_b32 v98, 3, v98
    s_mul_i32 s70, s61, 4224
    s_add_u32 s70, s70, 129184
    v_add_u32 v150, s70, v98
    s_lshl_b32 s70, s50, 11
    s_add_u32 s70, s70, 92160
    v_lshlrev_b32 v151, 4, v0
    v_add_u32 v151, s70, v151
    v_lshrrev_b32 v97, 4, v0
    v_lshrrev_b32 v98, 1, v99
    v_lshl_add_u32 v98, v97, 1, v98
    v_lshl_add_u32 v98, v98, 3, v96
    v_lshlrev_b32 v98, 4, v98
    v_and_b32 v99, 1, v99
    v_lshl_add_u32 v98, v99, 3, v98
    v_add_u32 v152, s70, v98
    v_and_b32 v98, 7, v0
    v_lshrrev_b32 v99, 5, v0
    v_lshl_add_u32 v98, v98, 1, v99
    v_mul_u32_u24 v98, 40960, v98
    v_bfe_u32 v99, v0, 3, 2
    v_lshl_add_u32 v154, v99, 4, v98
    s_lshl_b32 s70, s64, 4
    s_add_u32 s70, s70, 145920
    v_mov_b32 v153, s70
    s_lshl_b32 s70, s61, 2
    s_add_u32 s70, s70, 146064
    v_mov_b32 v155, s70
    s_lshr_b32 s66, s52, 1
    s_lshl_b32 s68, s53, 4
    s_add_u32 s68, s68, s66
    s_and_b32 s66, s52, 1
    s_lshl_b32 s69, s54, 1
    s_add_u32 s69, s69, s66
    v_lshlrev_b32 v1, 4, v0
    v_mov_b32 v13, 0
    v_and_b32 v24, 31, v0
    v_lshrrev_b32 v25, 5, v0
    s_and_b32 s66, s50, 3
    s_lshl_b32 s67, s66, 6
    s_lshl_b32 s70, s66, 4
    s_add_u32 s70, s70, 256
    s_cmp_lt_u32 s50, 4
    s_cselect_b32 s67, s67, s70
    s_cselect_b32 s71, 4, 3
    v_mul_u32_u24 v14, 1280, v24
    v_lshl_add_u32 v14, v25, s71, v14
    s_mul_i32 s96, s68, 40960
    s_mul_i32 s70, s69, 320
    s_add_u32 s100, s96, 5242880
    s_add_u32 s96, s96, s70
    s_add_u32 s96, s96, s67
    s_lshl_b32 s71, s68, 7
    s_add_u32 s71, s71, 8962048
    v_lshlrev_b32 v19, 2, v24
    v_add_u32 v19, s71, v19
    v_bfe_u32 v26, v0, 2, 2
    v_lshl_add_u32 v26, v25, 2, v26
    v_lshlrev_b32 v17, 6, v26
    v_bfe_u32 v26, v0, 4, 1
    v_lshl_add_u32 v17, v26, 5, v17
    v_and_b32 v26, 3, v0
    v_lshl_add_u32 v17, v26, 3, v17
    s_lshl_b32 s67, s67, 5
    s_add_u32 s67, s67, 146176
    v_add_u32 v17, s67, v17
    s_lshl_b32 s67, s66, 12
    s_add_u32 s67, s67, 77824
    v_add_u32 v5, s67, v1
    s_lshl_b32 s67, s66, 10
    s_add_u32 s67, s67, 94208
    v_add_u32 v15, s67, v1
    s_mul_i32 s67, s66, 10240
    s_add_u32 s67, s67, 36864
    v_add_u32 v4, s67, v1
    v_add_u32 v3, 36864, v1
    s_mul_i32 s67, s50, 5120
    s_add_u32 s70, s67, 36864
    v_add_u32 v2, s70, v1
    s_add_u32 s97, s100, s67
    s_add_u32 s97, s97, 4292345856
    v_mul_u32_u24 v25, 336, v25
    v_min_u32 v26, 20, v24
    v_lshl_add_u32 v26, v26, 4, v25
    v_lshrrev_b32 v27, 2, v24
    v_mov_b32 v18, 0x7f000000
    v_cmp_eq_u32 vcc, 5, v27
    v_subrev_u32 v10, 4, v24
    v_lshl_add_u32 v10, v10, 4, v25
    v_cndmask_b32 v9, v26, v18, vcc
    v_cndmask_b32 v10, v26, v10, vcc
    v_cmp_eq_u32 vcc, 4, v27
    s_mul_i32 s98, s50, 7168
    s_add_u32 s98, s98, 8716288
    v_cndmask_b32 v10, v10, v18, vcc
    s_lshl_b32 s67, s50, 8
    s_add_u32 s67, s67, 8781824
    v_lshrrev_b32 v11, 5, v0
    v_lshlrev_b32 v11, 10, v11
    v_add_u32 v11, s67, v11
    v_mov_b32 v27, v11
    s_lshr_b32 s67, s68, 1
    s_lshl_b32 s67, s67, 3
    s_add_u32 s67, s67, s50
    s_lshl_b32 s67, s67, 8
    s_add_u32 s67, s67, 8798208
    v_writelane_b32 v11, s67, 0
    s_add_u32 s67, s67, 1024
    v_writelane_b32 v11, s67, 1
    s_lshr_b32 s67, s68, 3
    s_add_u32 s67, s67, 2
    s_bfe_u32 s67, s67, 0x10002
    s_mul_i32 s67, s67, 20
    s_mul_i32 s70, s69, 5
    s_add_u32 s67, s67, s70
    s_lshl_b32 s67, s67, 8
    s_add_u32 s67, s67, 8784896
    v_mov_b32 v12, s67
    s_lshl_b32 s71, s66, 8
    s_add_u32 s67, s67, s71
    s_sub_u32 s67, s67, 1024
    v_writelane_b32 v12, s67, 0
    s_lshl_b32 s70, s70, 11
    s_add_u32 s100, s100, s70
    s_lshl_b32 s101, s66, 11
    s_and_b32 s70, s52, 1
    s_lshl_b32 s71, s54, 1
    s_add_u32 s70, s70, s71
    s_lshl_b32 s70, s70, 3
    s_add_u32 s70, s70, s50
    s_mul_i32 s70, s70, 25600
    s_add_u32 s2, s70, 7864320
    v_lshlrev_b32 v1, 4, v0
    v_mov_b32 v44, 128
    v_mov_b32 v45, 132
    v_mov_b32 v100, 0
    v_mov_b32 v101, 0
    v_lshlrev_b32 v102, 3, v0
    s_and_b32 s72, s64, 3
    s_lshl_b32 s70, s72, 9
    s_add_u32 s70, s70, 110592
    v_add_u32 v103, s70, v102
    ds_write_b64 v103, v[100:101]
    s_mul_i32 s70, s72, 4224
    s_add_u32 s70, s70, 129024
    v_add_u32 v103, s70, v102
    s_mov_b64 exec, 0xffff
    ds_write_b64 v103, v[100:101]
    v_add_u32 v103, 146048, v102
    s_mov_b64 exec, 0xff
    ds_write_b64 v103, v[100:101]
    s_mov_b64 exec, -1
    s_waitcnt lgkmcnt(0)
    s_and_b32 s70, s63, 1
    s_lshl_b32 s70, s70, 4
    s_lshr_b32 s77, s77, s70
    s_and_b32 s77, s77, 0xffff
    v_lshlrev_b32 v98, 2, v0
    v_and_b32 v98, 16, v98
    v_lshlrev_b32 v98, v98, s77
    v_and_b32 v99, 59, v0
    v_cmp_eq_u32 vcc, 32, v99
    s_nop 1
    v_cndmask_b32 v144, 0, v98, vcc
    v_cmp_eq_u32 vcc, 40, v99
    s_nop 1
    v_cndmask_b32 v145, 0, v98, vcc
    v_cmp_eq_u32 vcc, 48, v99
    s_nop 1
    v_cndmask_b32 v146, 0, v98, vcc
    v_cmp_eq_u32 vcc, 56, v99
    s_nop 1
    v_cndmask_b32 v147, 0, v98, vcc
    s_bitcmp1_b32 s76, 2
    s_cselect_b32 s74, 1, 3
    s_cselect_b32 s75, 9, 1
    s_and_b32 s74, s74, s76
    s_xor_b32 s74, s74, s75
    s_lshl_b32 s66, s74, 7
    s_add_u32 s66, s66, s58
    s_mul_i32 s67, s74, 245760
    s_add_u32 s67, s67, s65
    s_add_u32 m0, s99, 36864
    s_nop 0
    buffer_load_dwordx4 v32, s[4:7], s66 offen offset:0 lds
    s_bitcmp1_b32 s76, 2
    s_cselect_b32 s74, 7, 3
    s_cselect_b32 s75, 0, 2
    buffer_load_dwordx4 v33, s[4:7], s66 offen offset:1024 lds
    s_and_b32 s74, s74, s76
    s_xor_b32 s74, s74, s75
    s_lshl_b32 s68, s74, 7
    buffer_load_dwordx4 v34, s[4:7], s66 offen offset:2048 lds
    s_add_u32 s68, s68, s58
    s_mul_i32 s69, s74, 245760
    s_add_u32 s69, s69, s65
    buffer_load_dwordx4 v35, s[4:7], s66 offen offset:3072 lds
    s_add_u32 m0, s99, 53248
    s_nop 0
    buffer_load_dwordx4 v36, s[8:11], s67 offen offset:0 lds
    buffer_load_dwordx4 v37, s[8:11], s67 offen offset:1024 lds
    s_add_u32 m0, s57, 36864
    s_nop 0
    buffer_load_dwordx4 v40, s[8:11], s67 offen offset:0 lds
    s_add_u32 m0, s99, 53248
    s_nop 0
    buffer_load_dwordx4 v38, s[8:11], s67 offen offset:2048 lds
    buffer_load_dwordx4 v39, s[8:11], s67 offen offset:3072 lds
    s_add_u32 m0, s99, 73728
    s_waitcnt vmcnt(9)
    s_barrier
    buffer_load_dwordx4 v32, s[4:7], s68 offen offset:0 lds
    s_bitcmp1_b32 s76, 2
    s_cselect_b32 s74, 7, 3
    s_cselect_b32 s75, 1, 3
    buffer_load_dwordx4 v33, s[4:7], s68 offen offset:1024 lds
    s_and_b32 s74, s74, s76
    s_xor_b32 s74, s74, s75
    s_lshl_b32 s66, s74, 7
    buffer_load_dwordx4 v34, s[4:7], s68 offen offset:2048 lds
    s_add_u32 s66, s66, s58
    s_mul_i32 s67, s74, 245760
    s_add_u32 s67, s67, s65
    buffer_load_dwordx4 v35, s[4:7], s68 offen offset:3072 lds
    s_add_u32 m0, s99, 90112
    s_nop 0
    buffer_load_dwordx4 v36, s[8:11], s69 offen offset:0 lds
    buffer_load_dwordx4 v37, s[8:11], s69 offen offset:1024 lds
    s_add_u32 m0, s57, 73728
    s_nop 0
    buffer_load_dwordx4 v40, s[8:11], s69 offen offset:0 lds
    s_add_u32 m0, s99, 90112
    s_nop 0
    buffer_load_dwordx4 v38, s[8:11], s69 offen offset:2048 lds
    buffer_load_dwordx4 v39, s[8:11], s69 offen offset:3072 lds
    s_cmp_eq_u32 s1, 0
    s_cbranch_scc1 Lg_1
    s_bitcmp1_b32 s76, 2
    s_cselect_b32 s74, 1, 3
    s_cselect_b32 s75, 8, 0
    s_and_b32 s74, s74, s76
    s_xor_b32 s74, s74, s75
    s_lshl_b32 s74, s74, 7
    v_add_u32 v54, s74, v43
    ds_read_b128 v[56:59], v42 offset:0
    ds_read_b128 v[60:63], v54
    s_waitcnt lgkmcnt(0)
    v_dot2c_f32_bf16 v52, v56, v60
    v_dot2c_f32_bf16 v53, v57, v61
    v_dot2c_f32_bf16 v52, v58, v62
    v_dot2c_f32_bf16 v53, v59, v63
Lg_1:
    s_add_u32 m0, s99, 0
    s_waitcnt vmcnt(9)
    s_barrier
    buffer_load_dwordx4 v32, s[4:7], s66 offen offset:0 lds
    s_bitcmp1_b32 s76, 2
    s_cselect_b32 s74, 7, 3
    s_cselect_b32 s75, 2, 4
    buffer_load_dwordx4 v33, s[4:7], s66 offen offset:1024 lds
    s_and_b32 s74, s74, s76
    s_xor_b32 s74, s74, s75
    s_lshl_b32 s68, s74, 7
    buffer_load_dwordx4 v34, s[4:7], s66 offen offset:2048 lds
    s_add_u32 s68, s68, s58
    s_mul_i32 s69, s74, 245760
    s_add_u32 s69, s69, s65
    buffer_load_dwordx4 v35, s[4:7], s66 offen offset:3072 lds
    s_add_u32 m0, s99, 16384
    s_nop 0
    buffer_load_dwordx4 v36, s[8:11], s67 offen offset:0 lds
    buffer_load_dwordx4 v37, s[8:11], s67 offen offset:1024 lds
    s_add_u32 m0, s57, 0
    s_nop 0
    buffer_load_dwordx4 v40, s[8:11], s67 offen offset:0 lds
    s_add_u32 m0, s99, 16384
    s_nop 0
    buffer_load_dwordx4 v38, s[8:11], s67 offen offset:2048 lds
    buffer_load_dwordx4 v39, s[8:11], s67 offen offset:3072 lds
    s_cmp_eq_u32 s1, 0
    s_cbranch_scc1 Lg_2
    s_bitcmp1_b32 s76, 2
    s_cselect_b32 s74, 1, 3
    s_cselect_b32 s75, 9, 1
    s_and_b32 s74, s74, s76
    s_xor_b32 s74, s74, s75
    s_lshl_b32 s74, s74, 7
    v_add_u32 v54, s74, v43
    ds_read_b128 v[56:59], v42 offset:36864
    ds_read_b128 v[60:63], v54
    s_waitcnt lgkmcnt(0)
    v_dot2c_f32_bf16 v52, v56, v60
    v_dot2c_f32_bf16 v53, v57, v61
    v_dot2c_f32_bf16 v52, v58, v62
    v_dot2c_f32_bf16 v53, v59, v63
Lg_2:
    s_add_u32 m0, s99, 36864
    s_waitcnt vmcnt(9)
    s_barrier
    buffer_load_dwordx4 v32, s[4:7], s68 offen offset:0 lds
    s_bitcmp1_b32 s76, 2
    s_cselect_b32 s74, 7, 3
    s_cselect_b32 s75, 3, 5
    buffer_load_dwordx4 v33, s[4:7], s68 offen offset:1024 lds
    s_and_b32 s74, s74, s76
    s_xor_b32 s74, s74, s75
    s_lshl_b32 s66, s74, 7
    buffer_load_dwordx4 v34, s[4:7], s68 offen offset:2048 lds
    s_add_u32 s66, s66, s58
    s_mul_i32 s67, s74, 245760
    s_add_u32 s67, s67, s65
    buffer_load_dwordx4 v35, s[4:7], s68 offen offset:3072 lds
    s_add_u32 m0, s99, 53248
    s_nop 0
    buffer_load_dwordx4 v36, s[8:11], s69 offen offset:0 lds
    buffer_load_dwordx4 v37, s[8:11], s69 offen offset:1024 lds
    s_add_u32 m0, s57, 36864
    s_nop 0
    buffer_load_dwordx4 v40, s[8:11], s69 offen offset:0 lds
    s_add_u32 m0, s99, 53248
    s_nop 0
    buffer_load_dwordx4 v38, s[8:11], s69 offen offset:2048 lds
    buffer_load_dwordx4 v39, s[8:11], s69 offen offset:3072 lds
    s_cmp_eq_u32 s1, 0
    s_cbranch_scc1 Lg_3
    s_bitcmp1_b32 s76, 2
    s_cselect_b32 s74, 7, 3
    s_cselect_b32 s75, 0, 2
    s_and_b32 s74, s74, s76
    s_xor_b32 s74, s74, s75
    s_lshl_b32 s74, s74, 7
    v_add_u32 v54, s74, v43
    ds_read_b128 v[56:59], v55
    ds_read_b128 v[60:63], v54
    s_waitcnt lgkmcnt(0)
    v_dot2c_f32_bf16 v52, v56, v60
    v_dot2c_f32_bf16 v53, v57, v61
    v_dot2c_f32_bf16 v52, v58, v62
    v_dot2c_f32_bf16 v53, v59, v63
Lg_3:
    s_add_u32 m0, s99, 73728
    s_waitcnt vmcnt(9)
    s_barrier
    buffer_load_dwordx4 v32, s[4:7], s66 offen offset:0 lds
    s_bitcmp1_b32 s76, 2
    s_cselect_b32 s74, 7, 3
    s_cselect_b32 s75, 4, 6
    buffer_load_dwordx4 v33, s[4:7], s66 offen offset:1024 lds
    s_and_b32 s74, s74, s76
    s_xor_b32 s74, s74, s75
    s_lshl_b32 s68, s74, 7
    buffer_load_dwordx4 v34, s[4:7], s66 offen offset:2048 lds
    s_add_u32 s68, s68, s58
    s_mul_i32 s69, s74, 245760
    s_add_u32 s69, s69, s65
    buffer_load_dwordx4 v35, s[4:7], s66 offen offset:3072 lds
    s_add_u32 m0, s99, 90112
    s_nop 0
    buffer_load_dwordx4 v36, s[8:11], s67 offen offset:0 lds
    buffer_load_dwordx4 v37, s[8:11], s67 offen offset:1024 lds
    s_add_u32 m0, s57, 73728
    s_nop 0
    buffer_load_dwordx4 v40, s[8:11], s67 offen offset:0 lds
    s_add_u32 m0, s99, 90112
    s_nop 0
    buffer_load_dwordx4 v38, s[8:11], s67 offen offset:2048 lds
    buffer_load_dwordx4 v39, s[8:11], s67 offen offset:3072 lds
    s_cmp_eq_u32 s1, 0
    s_cbranch_scc1 Lg_4
    s_bitcmp1_b32 s76, 2
    s_cselect_b32 s74, 7, 3
    s_cselect_b32 s75, 1, 3
    s_and_b32 s74, s74, s76
    s_xor_b32 s74, s74, s75
    s_lshl_b32 s74, s74, 7
    v_add_u32 v54, s74, v43
    ds_read_b128 v[56:59], v42 offset:0
    ds_read_b128 v[60:63], v54
    s_waitcnt lgkmcnt(0)
    v_dot2c_f32_bf16 v52, v56, v60
    v_dot2c_f32_bf16 v53, v57, v61
    v_dot2c_f32_bf16 v52, v58, v62
    v_dot2c_f32_bf16 v53, v59, v63
Lg_4:
    s_add_u32 m0, s99, 0
    s_waitcnt vmcnt(9)
    s_barrier
    buffer_load_dwordx4 v32, s[4:7], s68 offen offset:0 lds
    s_bitcmp1_b32 s76, 2
    s_cselect_b32 s74, 7, 3
    s_cselect_b32 s75, 5, 7
    buffer_load_dwordx4 v33, s[4:7], s68 offen offset:1024 lds
    s_and_b32 s74, s74, s76
    s_xor_b32 s74, s74, s75
    s_lshl_b32 s66, s74, 7
    buffer_load_dwordx4 v34, s[4:7], s68 offen offset:2048 lds
    s_add_u32 s66, s66, s58
    s_mul_i32 s67, s74, 245760
    s_add_u32 s67, s67, s65
    buffer_load_dwordx4 v35, s[4:7], s68 offen offset:3072 lds
    s_add_u32 m0, s99, 16384
    s_nop 0
    buffer_load_dwordx4 v36, s[8:11], s69 offen offset:0 lds
    buffer_load_dwordx4 v37, s[8:11], s69 offen offset:1024 lds
    s_add_u32 m0, s57, 0
    s_nop 0
    buffer_load_dwordx4 v40, s[8:11], s69 offen offset:0 lds
    s_add_u32 m0, s99, 16384
    s_nop 0
    buffer_load_dwordx4 v38, s[8:11], s69 offen offset:2048 lds
    buffer_load_dwordx4 v39, s[8:11], s69 offen offset:3072 lds
    s_cmp_eq_u32 s1, 0
    s_cbranch_scc1 Lg_5
    s_bitcmp1_b32 s76, 2
    s_cselect_b32 s74, 7, 3
    s_cselect_b32 s75, 2, 4
    s_and_b32 s74, s74, s76
    s_xor_b32 s74, s74, s75
    s_lshl_b32 s74, s74, 7
    v_add_u32 v54, s74, v43
    ds_read_b128 v[56:59], v42 offset:36864
    ds_read_b128 v[60:63], v54
    s_waitcnt lgkmcnt(0)
    v_dot2c_f32_bf16 v52, v56, v60
    v_dot2c_f32_bf16 v53, v57, v61
    v_dot2c_f32_bf16 v52, v58, v62
    v_dot2c_f32_bf16 v53, v59, v63
Lg_5:
    s_add_u32 m0, s99, 36864
    s_waitcnt vmcnt(9)
    s_barrier
    buffer_load_dwordx4 v32, s[4:7], s66 offen offset:0 lds
    s_bitcmp1_b32 s76, 2
    s_cselect_b32 s74, 7, 1
    s_cselect_b32 s75, 6, 8
    buffer_load_dwordx4 v33, s[4:7], s66 offen offset:1024 lds
    s_and_b32 s74, s74, s76
    s_xor_b32 s74, s74, s75
    s_lshl_b32 s68, s74, 7
    buffer_load_dwordx4 v34, s[4:7], s66 offen offset:2048 lds
    s_add_u32 s68, s68, s58
    s_mul_i32 s69, s74, 245760
    s_add_u32 s69, s69, s65
    buffer_load_dwordx4 v35, s[4:7], s66 offen offset:3072 lds
    s_add_u32 m0, s99, 53248
    s_nop 0
    buffer_load_dwordx4 v36, s[8:11], s67 offen offset:0 lds
    buffer_load_dwordx4 v37, s[8:11], s67 offen offset:1024 lds
    s_add_u32 m0, s57, 36864
    s_nop 0
    buffer_load_dwordx4 v40, s[8:11], s67 offen offset:0 lds
    s_add_u32 m0, s99, 53248
    s_nop 0
    buffer_load_dwordx4 v38, s[8:11], s67 offen offset:2048 lds
    buffer_load_dwordx4 v39, s[8:11], s67 offen offset:3072 lds
    s_cmp_eq_u32 s1, 0
    s_cbranch_scc1 Lg_6
    s_bitcmp1_b32 s76, 2
    s_cselect_b32 s74, 7, 3
    s_cselect_b32 s75, 3, 5
    s_and_b32 s74, s74, s76
    s_xor_b32 s74, s74, s75
    s_lshl_b32 s74, s74, 7
    v_add_u32 v54, s74, v43
    ds_read_b128 v[56:59], v55
    ds_read_b128 v[60:63], v54
    s_waitcnt lgkmcnt(0)
    v_dot2c_f32_bf16 v52, v56, v60
    v_dot2c_f32_bf16 v53, v57, v61
    v_dot2c_f32_bf16 v52, v58, v62
    v_dot2c_f32_bf16 v53, v59, v63
Lg_6:
    s_add_u32 m0, s99, 73728
    s_waitcnt vmcnt(9)
    s_barrier
    buffer_load_dwordx4 v32, s[4:7], s68 offen offset:0 lds
    s_bitcmp1_b32 s76, 2
    s_cselect_b32 s74, 7, 1
    s_cselect_b32 s75, 7, 9
    buffer_load_dwordx4 v33, s[4:7], s68 offen offset:1024 lds
    s_and_b32 s74, s74, s76
    s_xor_b32 s74, s74, s75
    s_lshl_b32 s66, s74, 7
    buffer_load_dwordx4 v34, s[4:7], s68 offen offset:2048 lds
    s_add_u32 s66, s66, s58
    s_mul_i32 s67, s74, 245760
    s_add_u32 s67, s67, s65
    buffer_load_dwordx4 v35, s[4:7], s68 offen offset:3072 lds
    s_add_u32 m0, s99, 90112
    s_nop 0
    buffer_load_dwordx4 v36, s[8:11], s69 offen offset:0 lds
    buffer_load_dwordx4 v37, s[8:11], s69 offen offset:1024 lds
    s_add_u32 m0, s57, 73728
    s_nop 0
    buffer_load_dwordx4 v40, s[8:11], s69 offen offset:0 lds
    s_add_u32 m0, s99, 90112
    s_nop 0
    buffer_load_dwordx4 v38, s[8:11], s69 offen offset:2048 lds
    buffer_load_dwordx4 v39, s[8:11], s69 offen offset:3072 lds
    s_cmp_eq_u32 s1, 0
    s_cbranch_scc1 Lg_7
    s_bitcmp1_b32 s76, 2
    s_cselect_b32 s74, 7, 3
    s_cselect_b32 s75, 4, 6
    s_and_b32 s74, s74, s76
    s_xor_b32 s74, s74, s75
    s_lshl_b32 s74, s74, 7
    v_add_u32 v54, s74, v43
    ds_read_b128 v[56:59], v42 offset:0
    ds_read_b128 v[60:63], v54
    s_waitcnt lgkmcnt(0)
    v_dot2c_f32_bf16 v52, v56, v60
    v_dot2c_f32_bf16 v53, v57, v61
    v_dot2c_f32_bf16 v52, v58, v62
    v_dot2c_f32_bf16 v53, v59, v63
Lg_7:
    s_add_u32 m0, s99, 0
    s_waitcnt vmcnt(9)
    s_barrier
    buffer_load_dwordx4 v32, s[4:7], s66 offen offset:0 lds
    buffer_load_dwordx4 v33, s[4:7], s66 offen offset:1024 lds
    buffer_load_dwordx4 v34, s[4:7], s66 offen offset:2048 lds
    buffer_load_dwordx4 v35, s[4:7], s66 offen offset:3072 lds
    s_add_u32 m0, s99, 16384
    s_nop 0
    buffer_load_dwordx4 v36, s[8:11], s67 offen offset:0 lds
    buffer_load_dwordx4 v37, s[8:11], s67 offen offset:1024 lds
    s_add_u32 m0, s57, 0
    s_nop 0
    buffer_load_dwordx4 v40, s[8:11], s67 offen offset:0 lds
    s_add_u32 m0, s99, 16384
    s_nop 0
    buffer_load_dwordx4 v38, s[8:11], s67 offen offset:2048 lds
    buffer_load_dwordx4 v39, s[8:11], s67 offen offset:3072 lds
    s_cmp_eq_u32 s1, 0
    s_cbranch_scc1 Lg_8
    s_bitcmp1_b32 s76, 2
    s_cselect_b32 s74, 7, 3
    s_cselect_b32 s75, 5, 7
    s_and_b32 s74, s74, s76
    s_xor_b32 s74, s74, s75
    s_lshl_b32 s74, s74, 7
    v_add_u32 v54, s74, v43
    ds_read_b128 v[56:59], v42 offset:36864
    ds_read_b128 v[60:63], v54
    s_waitcnt lgkmcnt(0)
    v_dot2c_f32_bf16 v52, v56, v60
    v_dot2c_f32_bf16 v53, v57, v61
    v_dot2c_f32_bf16 v52, v58, v62
    v_dot2c_f32_bf16 v53, v59, v63
Lg_8:
    s_mov_b32 s79, 0x358637bd
    s_sub_u32 s67, s63, s61
    s_waitcnt vmcnt(9)
    s_barrier
    buffer_load_dwordx2 v[46:47], v44, s[40:43], 0 offen sc1
    s_lshr_b32 s70, s64, 1
    s_and_b32 s71, s64, 1
    s_lshl_b32 s71, s71, 11
    s_add_u32 s72, s67, s70
    s_lshl_b32 s72, s72, 12
    s_add_u32 s72, s72, s71
    s_mul_i32 s70, s70, 4224
    s_add_u32 s70, s70, s71
    s_add_u32 m0, s70, 129152
    s_nop 0
    buffer_load_dwordx4 v1, s[28:31], s72 offen lds
    buffer_load_dwordx4 v1, s[28:31], s72 offen offset:1024 lds
    s_cmp_eq_u32 s1, 0
    s_cbranch_scc1 Lg_9
    s_bitcmp1_b32 s76, 2
    s_cselect_b32 s74, 7, 1
    s_cselect_b32 s75, 6, 8
    s_and_b32 s74, s74, s76
    s_xor_b32 s74, s74, s75
    s_lshl_b32 s74, s74, 7
    v_add_u32 v54, s74, v43
    ds_read_b128 v[56:59], v55
    ds_read_b128 v[60:63], v54
    s_waitcnt lgkmcnt(0)
    v_dot2c_f32_bf16 v52, v56, v60
    v_dot2c_f32_bf16 v53, v57, v61
    v_dot2c_f32_bf16 v52, v58, v62
    v_dot2c_f32_bf16 v53, v59, v63
Lg_9:
    s_waitcnt vmcnt(3)
    s_barrier
    s_setprio 3
    s_cmp_eq_u32 s1, 0
    s_cbranch_scc1 Lg_10
    s_bitcmp1_b32 s76, 2
    s_cselect_b32 s74, 7, 1
    s_cselect_b32 s75, 7, 9
    s_and_b32 s74, s74, s76
    s_xor_b32 s74, s74, s75
    s_lshl_b32 s74, s74, 7
    v_add_u32 v54, s74, v43
    ds_read_b128 v[56:59], v42 offset:0
    ds_read_b128 v[60:63], v54
    s_waitcnt lgkmcnt(0)
    v_dot2c_f32_bf16 v52, v56, v60
    v_dot2c_f32_bf16 v53, v57, v61
    v_dot2c_f32_bf16 v52, v58, v62
    v_dot2c_f32_bf16 v53, v59, v63
Lg_10:
    s_cmp_eq_u32 s1, 0
    s_cbranch_scc1 Lbg
    s_nop 0
    v_add_f32 v52, v52, v53
    s_nop 1
    v_add_f32_dpp v52, v52, v52 quad_perm:[1,0,3,2] row_mask:0xf bank_mask:0xf
    s_nop 1
    v_add_f32_dpp v52, v52, v52 quad_perm:[2,3,0,1] row_mask:0xf bank_mask:0xf
    s_nop 1
    v_add_f32_dpp v52, v52, v52 row_half_mirror row_mask:0xf bank_mask:0xf
    v_mul_f32 v52, 0xbfb8aa3b, v52
    v_exp_f32 v52, v52
    v_lshrrev_b32 v53, 1, v0
    v_add_f32 v52, 1.0, v52
    v_rcp_f32 v52, v52
    s_lshl_b32 s66, s0, 5
    s_add_u32 s66, s66, 8962048
    s_mov_b32 exec_lo, 0x01010101
    s_mov_b32 exec_hi, 0x01010101
    buffer_store_dword v52, v53, s[44:47], s66 offen sc1
    s_mov_b64 exec, -1
Lbg:
    s_setprio 0
    s_waitcnt vmcnt(2)
    v_cmp_ne_u32 vcc, s55, v47
    s_cbranch_vccz Lpd_12
    s_mov_b32 s56, 0x20000
Lpoll_11:
    buffer_load_dword v47, v45, s[40:43], 0 offen sc1
    s_waitcnt vmcnt(0)
    v_cmp_ne_u32 vcc, s55, v47
    s_cbranch_vccz Lpd_12
    s_sleep 2
    s_sub_u32 s56, s56, 1
    s_cbranch_scc0 Lpoll_11
Lpd_12:
    v_mov_b32 v48, 146056
    v_readfirstlane_b32 s65, v46
    s_nop 0
    s_cmp_eq_u32 s65, 0
    s_cbranch_scc1 Lbl1
    s_mul_i32 s70, s64, 4096
    s_lshl_b32 s71, s59, 14
    s_add_u32 s71, s71, s70
    s_add_u32 m0, s70, 112640
    s_nop 0
    buffer_load_dwordx4 v1, s[44:47], s71 offen offset:0 sc1 lds
    buffer_load_dwordx4 v1, s[44:47], s71 offen offset:1024 sc1 lds
    buffer_load_dwordx4 v1, s[44:47], s71 offen offset:2048 sc1 lds
    buffer_load_dwordx4 v1, s[44:47], s71 offen offset:3072 sc1 lds
    buffer_load_dwordx4 v[156:159], v1, s[44:47], s2 offen offset:0 sc1
    buffer_load_dwordx4 v[160:163], v1, s[44:47], s2 offen offset:1024 sc1
    buffer_load_dwordx4 v[164:167], v1, s[44:47], s2 offen offset:2048 sc1
    buffer_load_dwordx4 v[168:171], v1, s[44:47], s2 offen offset:3072 sc1
    s_add_u32 s2, s2, 4096
    buffer_load_dwordx4 v[172:175], v1, s[44:47], s2 offen offset:0 sc1
    buffer_load_dwordx4 v[176:179], v1, s[44:47], s2 offen offset:1024 sc1
    buffer_load_dwordx4 v[180:183], v1, s[44:47], s2 offen offset:2048 sc1
    buffer_load_dwordx4 v[184:187], v1, s[44:47], s2 offen offset:3072 sc1
    s_add_u32 s2, s2, 4096
    s_branch Lbl1b
Lbl1:
    buffer_load_dword v46, v44, s[40:43], 0 offen sc1
    buffer_load_dwordx4 v[156:159], v1, s[44:47], s2 offen offset:0 sc1
    buffer_load_dwordx4 v[160:163], v1, s[44:47], s2 offen offset:1024 sc1
    buffer_load_dwordx4 v[164:167], v1, s[44:47], s2 offen offset:2048 sc1
    buffer_load_dwordx4 v[168:171], v1, s[44:47], s2 offen offset:3072 sc1
    s_add_u32 s2, s2, 4096
    buffer_load_dwordx4 v[172:175], v1, s[44:47], s2 offen offset:0 sc1
    buffer_load_dwordx4 v[176:179], v1, s[44:47], s2 offen offset:1024 sc1
    buffer_load_dwordx4 v[180:183], v1, s[44:47], s2 offen offset:2048 sc1
    buffer_load_dwordx4 v[184:187], v1, s[44:47], s2 offen offset:3072 sc1
    s_add_u32 s2, s2, 4096
    s_waitcnt vmcnt(8)
    v_readfirstlane_b32 s65, v46
    s_nop 0
    s_cmp_eq_u32 s65, 0
    s_cbranch_scc1 Lbl1b
    s_mul_i32 s70, s64, 4096
    s_lshl_b32 s71, s59, 14
    s_add_u32 s71, s71, s70
    s_add_u32 m0, s70, 112640
    s_nop 0
    buffer_load_dwordx4 v1, s[44:47], s71 offen offset:0 sc1 lds
    buffer_load_dwordx4 v1, s[44:47], s71 offen offset:1024 sc1 lds
    buffer_load_dwordx4 v1, s[44:47], s71 offen offset:2048 sc1 lds
    buffer_load_dwordx4 v1, s[44:47], s71 offen offset:3072 sc1 lds
Lbl1b:
    s_cmp_eq_u32 s1, 0
    s_cbranch_scc1 Lbg1
    v_mov_b32 v50, 146048
    s_waitcnt vmcnt(8)
    v_mov_b32 v51, 1
    s_mov_b64 exec, 1
    ds_add_u32 v50, v51
    s_mov_b64 exec, -1
Lbg1:
    buffer_load_dwordx4 v[188:191], v1, s[44:47], s2 offen offset:0 sc1
    buffer_load_dwordx4 v[192:195], v1, s[44:47], s2 offen offset:1024 sc1
    buffer_load_dwordx4 v[196:199], v1, s[44:47], s2 offen offset:2048 sc1
    buffer_load_dwordx4 v[200:203], v1, s[44:47], s2 offen offset:3072 sc1
    s_add_u32 s2, s2, 4096
    buffer_load_dwordx4 v[204:207], v1, s[44:47], s2 offen offset:0 sc1
    buffer_load_dwordx4 v[208:211], v1, s[44:47], s2 offen offset:1024 sc1
    buffer_load_dwordx4 v[212:215], v1, s[44:47], s2 offen offset:2048 sc1
    buffer_load_dwordx4 v[216:219], v1, s[44:47], s2 offen offset:3072 sc1
    s_add_u32 s2, s2, 4096
    s_cmp_lg_u32 s65, 0
    s_cbranch_scc1 Lbl2
    buffer_load_dword v46, v44, s[40:43], 0 offen sc1
Lbl2:
    buffer_load_dwordx4 v[220:223], v1, s[44:47], s2 offen offset:0 sc1
    buffer_load_dwordx4 v[224:227], v1, s[44:47], s2 offen offset:1024 sc1
    buffer_load_dwordx4 v[228:231], v1, s[44:47], s2 offen offset:2048 sc1
    buffer_load_dwordx4 v[232:235], v1, s[44:47], s2 offen offset:3072 sc1
    s_add_u32 s2, s2, 4096
    buffer_load_dwordx4 v[236:239], v1, s[44:47], s2 offen offset:0 sc1
    buffer_load_dwordx4 v[240:243], v1, s[44:47], s2 offen offset:1024 sc1
    buffer_load_dwordx4 v[244:247], v1, s[44:47], s2 offen offset:2048 sc1
    buffer_load_dwordx4 v[248:251], v1, s[44:47], s2 offen offset:3072 sc1
    s_add_u32 s2, s2, 4096
    buffer_load_dwordx4 v[252:255], v1, s[44:47], s2 offen offset:0 sc1
    s_cmp_ge_u32 s50, 4
    s_cbranch_scc1 Lxe_13
    buffer_load_dwordx4 v[20:23], v14, s[4:7], s96 offen
    buffer_load_dwordx4 v[28:31], v14, s[4:7], s96 offen offset:32
    s_branch Lxd_14
Lxe_13:
    buffer_load_dword v20, v14, s[4:7], s96 offen
    buffer_load_dword v21, v14, s[4:7], s96 offen offset:4
Lxd_14:
    s_waitcnt vmcnt(11)
    s_cmp_lg_u32 s65, 0
    s_cbranch_scc1 Lbl3
    v_readfirstlane_b32 s66, v46
    s_nop 0
    s_cmp_eq_u32 s66, 0
    s_cbranch_scc1 Lbl4
    s_mul_i32 s70, s64, 4096
    s_lshl_b32 s71, s59, 14
    s_add_u32 s71, s71, s70
    s_add_u32 m0, s70, 112640
    s_nop 0
    buffer_load_dwordx4 v1, s[44:47], s71 offen offset:0 sc1 lds
    buffer_load_dwordx4 v1, s[44:47], s71 offen offset:1024 sc1 lds
    buffer_load_dwordx4 v1, s[44:47], s71 offen offset:2048 sc1 lds
    buffer_load_dwordx4 v1, s[44:47], s71 offen offset:3072 sc1 lds
    s_barrier
    s_branch Lbl5
Lbl4:
    s_barrier
    s_mov_b32 s56, 0x20000
Lpoll_15:
    buffer_load_dword v46, v44, s[40:43], 0 offen sc1
    s_waitcnt vmcnt(0)
    v_cmp_ne_u32 vcc, s55, v46
    s_cbranch_vccz Lpd_16
    s_sleep 2
    s_sub_u32 s56, s56, 1
    s_cbranch_scc0 Lpoll_15
Lpd_16:
    s_mul_i32 s70, s64, 4096
    s_lshl_b32 s71, s59, 14
    s_add_u32 s71, s71, s70
    s_add_u32 m0, s70, 112640
    s_nop 0
    buffer_load_dwordx4 v1, s[44:47], s71 offen offset:0 sc1 lds
    buffer_load_dwordx4 v1, s[44:47], s71 offen offset:1024 sc1 lds
    buffer_load_dwordx4 v1, s[44:47], s71 offen offset:2048 sc1 lds
    buffer_load_dwordx4 v1, s[44:47], s71 offen offset:3072 sc1 lds
Lbl5:
    s_waitcnt vmcnt(0)
    v_mov_b32 v49, 1
    s_mov_b64 exec, 1
    ds_add_u32 v48, v49
    s_mov_b64 exec, -1
    s_branch Lbl6
Lbl3:
    v_mov_b32 v49, 1
    s_mov_b64 exec, 1
    ds_add_u32 v48, v49
    s_mov_b64 exec, -1
    s_barrier
Lbl6:
    s_mov_b32 s56, 0x400000
Lls_17:
    ds_read_b32 v49, v48
    s_waitcnt lgkmcnt(0)
    v_readfirstlane_b32 s73, v49
    s_nop 0
    s_cmp_ge_u32 s73, 4
    s_cbranch_scc1 Lld_18
    s_sub_u32 s56, s56, 1
    s_cbranch_scc0 Lls_17
Lld_18:
    s_branch Lconv
Lawave:
    s_cmp_ge_u32 s52, 16
    s_cbranch_scc1 Lqa
    s_mov_b32 s46, 9437184
    s_mov_b32 s47, 0x20000
    s_mov_b32 s42, 256
    s_mov_b32 s43, 0x20000
    s_mov_b32 s74, 0x3fb8aa3b
    s_mov_b32 s75, 0x3fb8aa3b
    s_mov_b32 s79, 0x358637bd
    s_mul_i32 s66, s54, 8
    s_lshl_b32 s76, s53, 4
    s_add_u32 s76, s76, s66
    s_add_u32 s76, s76, s52
    s_sub_u32 s76, s76, s51
    s_mov_b32 s6, 2621440
    s_mov_b32 s7, 0x20000
    s_mov_b32 s38, 2621440
    s_mov_b32 s39, 0x20000
    v_mov_b32 v32, 0
    v_mov_b32 v33, 0
    v_mov_b32 v34, 0
    v_mov_b32 v35, 0
    v_mov_b32 v36, 0
    v_mov_b32 v37, 0
    v_mov_b32 v38, 0
    v_mov_b32 v39, 0
    v_mov_b32 v40, 0
    v_mov_b32 v41, 0
    v_mov_b32 v42, 0
    v_mov_b32 v43, 0
    v_mov_b32 v44, 0
    v_mov_b32 v45, 0
    v_mov_b32 v46, 0
    v_mov_b32 v47, 0
    v_mov_b32 v48, 0
    v_mov_b32 v49, 0
    v_mov_b32 v50, 0
    v_mov_b32 v51, 0
    v_mov_b32 v52, 0
    v_mov_b32 v53, 0
    v_mov_b32 v54, 0
    v_mov_b32 v55, 0
    v_mov_b32 v56, 0
    v_mov_b32 v57, 0
    v_mov_b32 v58, 0
    v_mov_b32 v59, 0
    v_mov_b32 v60, 0
    v_mov_b32 v61, 0
    v_mov_b32 v62, 0
    v_mov_b32 v63, 0
    v_mov_b32 v64, 0
    v_mov_b32 v65, 0
    v_mov_b32 v66, 0
    v_mov_b32 v67, 0
    v_mov_b32 v68, 0
    v_mov_b32 v69, 0
    v_mov_b32 v70, 0
    v_mov_b32 v71, 0
    v_mov_b32 v72, 0
    v_mov_b32 v73, 0
    v_mov_b32 v74, 0
    v_mov_b32 v75, 0
    v_mov_b32 v76, 0
    v_mov_b32 v77, 0
    v_mov_b32 v78, 0
    v_mov_b32 v79, 0
    v_mov_b32 v80, 0
    v_mov_b32 v81, 0
    v_mov_b32 v82, 0
    v_mov_b32 v83, 0
    v_mov_b32 v84, 0
    v_mov_b32 v85, 0
    v_mov_b32 v86, 0
    v_mov_b32 v87, 0
    v_mov_b32 v88, 0
    v_mov_b32 v89, 0
    v_mov_b32 v90, 0
    v_mov_b32 v91, 0
    v_mov_b32 v92, 0
    v_mov_b32 v93, 0
    v_mov_b32 v94, 0
    v_mov_b32 v95, 0
    v_mov_b32 v96, 0
    v_mov_b32 v97, 0
    v_mov_b32 v98, 0
    v_mov_b32 v99, 0
    v_mov_b32 v100, 0
    v_mov_b32 v101, 0
    v_mov_b32 v102, 0
    v_mov_b32 v103, 0
    v_mov_b32 v104, 0
    v_mov_b32 v105, 0
    v_mov_b32 v106, 0
    v_mov_b32 v107, 0
    v_mov_b32 v108, 0
    v_mov_b32 v109, 0
    v_mov_b32 v110, 0
    v_mov_b32 v111, 0
    s_lshr_b32 s66, s52, 2
    s_lshl_b32 s58, s54, 2
    s_add_u32 s58, s58, s66
    s_and_b32 s66, s50, 1
    s_lshr_b32 s67, s50, 1
    v_and_b32 v18, 15, v0
    v_lshrrev_b32 v19, 4, v0
    v_lshrrev_b32 v8, 1, v18
    v_xor_b32 v8, v19, v8
    v_lshlrev_b32 v8, 4, v8
    v_lshl_add_u32 v8, v18, 7, v8
    s_lshl_b32 s70, s67, 13
    v_add_u32 v148, s70, v8
    v_xor_b32 v149, 64, v148
    v_bfe_u32 v8, v0, 2, 2
    v_lshl_add_u32 v9, v19, 3, v8
    v_and_b32 v10, 1, v19
    v_xor_b32 v10, s66, v10
    v_and_b32 v11, 3, v0
    v_lshlrev_b32 v11, 3, v11
    v_lshl_add_u32 v154, v9, 6, v11
    v_lshl_add_u32 v154, v10, 5, v154
    v_add_u32 v154, 32768, v154
    v_lshl_or_b32 v8, v10, 2, v8
    v_lshl_add_u32 v8, v8, 5, v11
    v_lshl_add_u32 v8, v9, 8, v8
    v_add_u32 v150, 16384, v8
    v_xor_b32 v151, 32, v150
    v_xor_b32 v152, 64, v150
    v_xor_b32 v153, 96, v150
    s_mul_i32 s70, s50, 3584
    s_add_u32 s70, s70, 77824
    v_mul_u32_u24 v8, 336, v19
    v_add_u32 v8, s70, v8
    v_lshl_add_u32 v16, v18, 4, v8
    v_add_u32 v9, 8, v18
    v_subrev_u32 v10, 12, v18
    v_cmp_lt_u32 vcc, 11, v18
    s_nop 1
    v_cndmask_b32 v9, v9, v10, vcc
    v_cmp_eq_u32 vcc, 0, v18
    v_mov_b32 v10, 20
    s_nop 0
    v_cndmask_b32 v9, v9, v10, vcc
    v_lshl_add_u32 v17, v9, 4, v8
    s_lshl_b32 s70, s66, 2
    s_add_u32 s70, s70, 146048
    v_mov_b32 v20, s70
    s_mul_i32 s70, s66, 3584
    s_mul_i32 s71, s67, 1792
    s_add_u32 s70, s70, s71
    v_lshlrev_b32 v21, 2, v0
    s_add_u32 s71, s70, 77824
    v_add_u32 v22, s71, v21
    s_mul_i32 s71, s58, 7168
    s_add_u32 s70, s70, s71
    s_add_u32 s63, s70, 8716288
    v_mov_b32 v23, 0x3f803f80
    s_lshl_b32 s61, s58, 8
    s_add_u32 s61, s61, 8781824
    s_and_b32 s70, s52, 1
    s_lshl_b32 s71, s54, 1
    s_add_u32 s70, s70, s71
    s_lshl_b32 s70, s70, 3
    s_add_u32 s70, s70, s50
    s_mul_i32 s70, s70, 25600
    s_add_u32 s2, s70, 7864320
    v_lshlrev_b32 v28, 4, v0
    s_mov_b32 s68, 0
    s_mov_b32 s69, 0
    s_mov_b32 s72, 1024
    s_waitcnt lgkmcnt(0)
    s_barrier
    ds_read_b128 v[112:115], v148 offset:0
    ds_read_b64_tr_b16 v[128:129], v150 offset:0
    ds_read_b64_tr_b16 v[130:131], v150 offset:1024
    ds_read_b128 v[116:119], v148 offset:2048
    ds_read_b64_tr_b16 v[132:133], v151 offset:0
    ds_read_b64_tr_b16 v[134:135], v151 offset:1024
    ds_read_b128 v[120:123], v148 offset:4096
    ds_read_b64_tr_b16 v[136:137], v152 offset:0
    ds_read_b64_tr_b16 v[138:139], v152 offset:1024
    ds_read_b128 v[124:127], v148 offset:6144
    ds_read_b64_tr_b16 v[140:141], v153 offset:0
    ds_read_b64_tr_b16 v[142:143], v153 offset:1024
    ds_read_b64_tr_b16 v[144:145], v154 offset:0
    ds_read_b64_tr_b16 v[146:147], v154 offset:256
.p2align 3
Lmlk:
    s_waitcnt lgkmcnt(0)
    v_mfma_f32_16x16x32_bf16 v[32:35], v[112:115], v[128:131], v[32:35]
    ds_read_b128 v[156:159], v149 offset:0
    v_mfma_f32_16x16x32_bf16 v[52:55], v[116:119], v[128:131], v[52:55]
    ds_read_b64_tr_b16 v[172:173], v150 offset:8192
    v_mfma_f32_16x16x32_bf16 v[72:75], v[120:123], v[128:131], v[72:75]
    ds_read_b64_tr_b16 v[174:175], v150 offset:9216
    s_add_u32 s69, s69, 1
    s_cmp_eq_u32 s69, 3
    v_mfma_f32_16x16x32_bf16 v[92:95], v[124:127], v[128:131], v[92:95]
    ds_read_b128 v[160:163], v149 offset:2048
    s_mov_b32 s70, 36864
    v_mfma_f32_16x16x32_bf16 v[36:39], v[112:115], v[132:135], v[36:39]
    ds_read_b64_tr_b16 v[176:177], v151 offset:8192
    s_cselect_b32 s70, 4294893568, s70
    v_mfma_f32_16x16x32_bf16 v[56:59], v[116:119], v[132:135], v[56:59]
    ds_read_b64_tr_b16 v[178:179], v151 offset:9216
    s_cselect_b32 s69, 0, s69
    s_add_u32 s68, s68, 1
    v_mfma_f32_16x16x32_bf16 v[76:79], v[120:123], v[132:135], v[76:79]
    ds_read_b128 v[164:167], v149 offset:4096
    v_mfma_f32_16x16x32_bf16 v[96:99], v[124:127], v[132:135], v[96:99]
    ds_read_b64_tr_b16 v[180:181], v152 offset:8192
    v_mfma_f32_16x16x32_bf16 v[40:43], v[112:115], v[136:139], v[40:43]
    ds_read_b64_tr_b16 v[182:183], v152 offset:9216
    v_mfma_f32_16x16x32_bf16 v[60:63], v[116:119], v[136:139], v[60:63]
    ds_read_b128 v[168:171], v149 offset:6144
    v_mfma_f32_16x16x32_bf16 v[80:83], v[120:123], v[136:139], v[80:83]
    ds_read_b64_tr_b16 v[184:185], v153 offset:8192
    v_mfma_f32_16x16x32_bf16 v[100:103], v[124:127], v[136:139], v[100:103]
    ds_read_b64_tr_b16 v[186:187], v153 offset:9216
    v_mfma_f32_16x16x32_bf16 v[44:47], v[112:115], v[140:143], v[44:47]
    ds_read_b64_tr_b16 v[188:189], v154 offset:2048
    v_mfma_f32_16x16x32_bf16 v[64:67], v[116:119], v[140:143], v[64:67]
    ds_read_b64_tr_b16 v[190:191], v154 offset:2304
    v_mfma_f32_16x16x32_bf16 v[84:87], v[120:123], v[140:143], v[84:87]
    v_add_u32 v148, s70, v148
    v_add_u32 v149, s70, v149
    v_mfma_f32_16x16x32_bf16 v[104:107], v[124:127], v[140:143], v[104:107]
    v_add_u32 v150, s70, v150
    v_add_u32 v151, s70, v151
    v_mfma_f32_16x16x32_bf16 v[48:51], v[112:115], v[144:147], v[48:51]
    v_add_u32 v152, s70, v152
    v_add_u32 v153, s70, v153
    v_mfma_f32_16x16x32_bf16 v[68:71], v[116:119], v[144:147], v[68:71]
    v_add_u32 v154, s70, v154
    s_bitcmp1_b32 s72, s68
    v_mfma_f32_16x16x32_bf16 v[88:91], v[120:123], v[144:147], v[88:91]
    v_mfma_f32_16x16x32_bf16 v[108:111], v[124:127], v[144:147], v[108:111]
    s_waitcnt lgkmcnt(0)
    s_cbranch_scc1 Lhookk
Lhookdk:
    s_barrier
    v_mfma_f32_16x16x32_bf16 v[32:35], v[156:159], v[172:175], v[32:35]
    ds_read_b128 v[112:115], v148 offset:0
    v_mfma_f32_16x16x32_bf16 v[52:55], v[160:163], v[172:175], v[52:55]
    ds_read_b64_tr_b16 v[128:129], v150 offset:0
    v_mfma_f32_16x16x32_bf16 v[72:75], v[164:167], v[172:175], v[72:75]
    ds_read_b64_tr_b16 v[130:131], v150 offset:1024
    v_mfma_f32_16x16x32_bf16 v[92:95], v[168:171], v[172:175], v[92:95]
    ds_read_b128 v[116:119], v148 offset:2048
    v_mfma_f32_16x16x32_bf16 v[36:39], v[156:159], v[176:179], v[36:39]
    ds_read_b64_tr_b16 v[132:133], v151 offset:0
    v_mfma_f32_16x16x32_bf16 v[56:59], v[160:163], v[176:179], v[56:59]
    ds_read_b64_tr_b16 v[134:135], v151 offset:1024
    v_mfma_f32_16x16x32_bf16 v[76:79], v[164:167], v[176:179], v[76:79]
    ds_read_b128 v[120:123], v148 offset:4096
    v_mfma_f32_16x16x32_bf16 v[96:99], v[168:171], v[176:179], v[96:99]
    ds_read_b64_tr_b16 v[136:137], v152 offset:0
    v_mfma_f32_16x16x32_bf16 v[40:43], v[156:159], v[180:183], v[40:43]
    ds_read_b64_tr_b16 v[138:139], v152 offset:1024
    v_mfma_f32_16x16x32_bf16 v[60:63], v[160:163], v[180:183], v[60:63]
    ds_read_b128 v[124:127], v148 offset:6144
    v_mfma_f32_16x16x32_bf16 v[80:83], v[164:167], v[180:183], v[80:83]
    ds_read_b64_tr_b16 v[140:141], v153 offset:0
    v_mfma_f32_16x16x32_bf16 v[100:103], v[168:171], v[180:183], v[100:103]
    ds_read_b64_tr_b16 v[142:143], v153 offset:1024
    v_mfma_f32_16x16x32_bf16 v[44:47], v[156:159], v[184:187], v[44:47]
    ds_read_b64_tr_b16 v[144:145], v154 offset:0
    v_mfma_f32_16x16x32_bf16 v[64:67], v[160:163], v[184:187], v[64:67]
    ds_read_b64_tr_b16 v[146:147], v154 offset:256
    v_mfma_f32_16x16x32_bf16 v[84:87], v[164:167], v[184:187], v[84:87]
    v_mfma_f32_16x16x32_bf16 v[104:107], v[168:171], v[184:187], v[104:107]
    v_mfma_f32_16x16x32_bf16 v[48:51], v[156:159], v[188:191], v[48:51]
    v_mfma_f32_16x16x32_bf16 v[68:71], v[160:163], v[188:191], v[68:71]
    v_mfma_f32_16x16x32_bf16 v[88:91], v[164:167], v[188:191], v[88:91]
    v_mfma_f32_16x16x32_bf16 v[108:111], v[168:171], v[188:191], v[108:111]
    s_branch Lmlk
Lhookk:
    v_mfma_f32_16x16x32_bf16 v[48:51], v[156:159], v[188:191], v[48:51]
    v_mfma_f32_16x16x32_bf16 v[68:71], v[160:163], v[188:191], v[68:71]
    v_mfma_f32_16x16x32_bf16 v[88:91], v[164:167], v[188:191], v[88:91]
    v_mfma_f32_16x16x32_bf16 v[108:111], v[168:171], v[188:191], v[108:111]
    v_mfma_f32_16x16x32_bf16 v[32:35], v[156:159], v[172:175], v[32:35]
    v_mfma_f32_16x16x32_bf16 v[52:55], v[160:163], v[172:175], v[52:55]
    v_mfma_f32_16x16x32_bf16 v[72:75], v[164:167], v[172:175], v[72:75]
    v_mfma_f32_16x16x32_bf16 v[92:95], v[168:171], v[172:175], v[92:95]
    v_cmp_gt_u32 vcc, 8, v18
    v_mfma_f32_16x16x32_bf16 v[40:43], v[156:159], v[180:183], v[40:43]
    v_cvt_pk_bf16_f32 v112, v48, v49
    v_cvt_pk_bf16_f32 v113, v50, v51
    v_mfma_f32_16x16x32_bf16 v[60:63], v[160:163], v[180:183], v[60:63]
    v_cvt_pk_bf16_f32 v114, v68, v69
    v_cvt_pk_bf16_f32 v115, v70, v71
    v_mfma_f32_16x16x32_bf16 v[80:83], v[164:167], v[180:183], v[80:83]
    v_cvt_pk_bf16_f32 v116, v88, v89
    v_cvt_pk_bf16_f32 v117, v90, v91
    v_mfma_f32_16x16x32_bf16 v[100:103], v[168:171], v[180:183], v[100:103]
    v_cvt_pk_bf16_f32 v118, v108, v109
    v_cvt_pk_bf16_f32 v119, v110, v111
    v_mfma_f32_16x16x32_bf16 v[36:39], v[156:159], v[176:179], v[36:39]
    v_cndmask_b32 v112, v112, v23, vcc
    v_cndmask_b32 v113, v113, v23, vcc
    v_mfma_f32_16x16x32_bf16 v[56:59], v[160:163], v[176:179], v[56:59]
    v_cndmask_b32 v114, v114, v23, vcc
    v_cndmask_b32 v115, v115, v23, vcc
    v_mfma_f32_16x16x32_bf16 v[76:79], v[164:167], v[176:179], v[76:79]
    v_cndmask_b32 v116, v116, v23, vcc
    v_cndmask_b32 v117, v117, v23, vcc
    v_mfma_f32_16x16x32_bf16 v[96:99], v[168:171], v[176:179], v[96:99]
    v_cndmask_b32 v118, v118, v23, vcc
    v_cndmask_b32 v119, v119, v23, vcc
    v_mfma_f32_16x16x32_bf16 v[44:47], v[156:159], v[184:187], v[44:47]
    v_mul_f32 v8, s74, v48
    v_mul_f32 v9, s74, v49
    v_mfma_f32_16x16x32_bf16 v[64:67], v[160:163], v[184:187], v[64:67]
    v_mul_f32 v10, s74, v50
    v_mul_f32 v11, s74, v51
    v_mfma_f32_16x16x32_bf16 v[84:87], v[164:167], v[184:187], v[84:87]
    v_mul_f32 v12, s74, v68
    v_mul_f32 v13, s74, v69
    v_mfma_f32_16x16x32_bf16 v[104:107], v[168:171], v[184:187], v[104:107]
    v_mul_f32 v14, s74, v70
    v_mul_f32 v15, s74, v71
    v_exp_f32_e64 v8, v8 clamp
    v_exp_f32_e64 v9, v9 clamp
    v_exp_f32_e64 v10, v10 clamp
    v_exp_f32_e64 v11, v11 clamp
    v_exp_f32_e64 v12, v12 clamp
    v_exp_f32_e64 v13, v13 clamp
    v_exp_f32_e64 v14, v14 clamp
    v_exp_f32_e64 v15, v15 clamp
    v_max_f32 v48, s79, v48
    v_max_f32 v49, s79, v49
    v_max_f32 v50, s79, v50
    v_max_f32 v51, s79, v51
    v_max_f32 v68, s79, v68
    v_max_f32 v69, s79, v69
    v_max_f32 v70, s79, v70
    v_max_f32 v71, s79, v71
    v_add_f32 v48, v48, v8
    v_add_f32 v49, v49, v9
    v_add_f32 v50, v50, v10
    v_add_f32 v51, v51, v11
    v_add_f32 v68, v68, v12
    v_add_f32 v69, v69, v13
    v_add_f32 v70, v70, v14
    v_add_f32 v71, v71, v15
    v_pk_mul_f32 v[8:9], v[88:89], s[74:75]
    v_pk_mul_f32 v[10:11], v[90:91], s[74:75]
    v_pk_mul_f32 v[12:13], v[108:109], s[74:75]
    v_pk_mul_f32 v[14:15], v[110:111], s[74:75]
    v_exp_f32_e64 v8, v8 clamp
    v_exp_f32_e64 v9, v9 clamp
    v_exp_f32_e64 v10, v10 clamp
    v_exp_f32_e64 v11, v11 clamp
    v_exp_f32_e64 v12, v12 clamp
    v_exp_f32_e64 v13, v13 clamp
    v_exp_f32_e64 v14, v14 clamp
    v_exp_f32_e64 v15, v15 clamp
    v_max_f32 v88, s79, v88
    v_max_f32 v89, s79, v89
    v_max_f32 v90, s79, v90
    v_max_f32 v91, s79, v91
    v_max_f32 v108, s79, v108
    v_max_f32 v109, s79, v109
    v_max_f32 v110, s79, v110
    v_max_f32 v111, s79, v111
    v_pk_add_f32 v[88:89], v[88:89], v[8:9]
    v_pk_add_f32 v[90:91], v[90:91], v[10:11]
    v_pk_add_f32 v[108:109], v[108:109], v[12:13]
    v_pk_add_f32 v[110:111], v[110:111], v[14:15]
    v_cvt_pk_bf16_f32 v48, v48, v49
    v_cvt_pk_bf16_f32 v49, v50, v51
    v_cvt_pk_bf16_f32 v50, v68, v69
    v_cvt_pk_bf16_f32 v51, v70, v71
    v_cvt_pk_bf16_f32 v88, v88, v89
    v_cvt_pk_bf16_f32 v89, v90, v91
    v_cvt_pk_bf16_f32 v90, v108, v109
    v_cvt_pk_bf16_f32 v91, v110, v111
    v_pk_mul_f32 v[8:9], v[32:33], s[74:75]
    v_pk_mul_f32 v[10:11], v[34:35], s[74:75]
    v_pk_mul_f32 v[12:13], v[52:53], s[74:75]
    v_pk_mul_f32 v[14:15], v[54:55], s[74:75]
    v_exp_f32_e64 v8, v8 clamp
    v_exp_f32_e64 v9, v9 clamp
    v_exp_f32_e64 v10, v10 clamp
    v_exp_f32_e64 v11, v11 clamp
    v_exp_f32_e64 v12, v12 clamp
    v_exp_f32_e64 v13, v13 clamp
    v_exp_f32_e64 v14, v14 clamp
    v_exp_f32_e64 v15, v15 clamp
    v_max_f32 v32, s79, v32
    v_max_f32 v33, s79, v33
    v_max_f32 v34, s79, v34
    v_max_f32 v35, s79, v35
    v_max_f32 v52, s79, v52
    v_max_f32 v53, s79, v53
    v_max_f32 v54, s79, v54
    v_max_f32 v55, s79, v55
    v_pk_add_f32 v[32:33], v[32:33], v[8:9]
    v_pk_add_f32 v[34:35], v[34:35], v[10:11]
    v_pk_add_f32 v[52:53], v[52:53], v[12:13]
    v_pk_add_f32 v[54:55], v[54:55], v[14:15]
    v_pk_mul_f32 v[8:9], v[72:73], s[74:75]
    v_pk_mul_f32 v[10:11], v[74:75], s[74:75]
    v_pk_mul_f32 v[12:13], v[92:93], s[74:75]
    v_pk_mul_f32 v[14:15], v[94:95], s[74:75]
    v_exp_f32_e64 v8, v8 clamp
    v_exp_f32_e64 v9, v9 clamp
    v_exp_f32_e64 v10, v10 clamp
    v_exp_f32_e64 v11, v11 clamp
    v_exp_f32_e64 v12, v12 clamp
    v_exp_f32_e64 v13, v13 clamp
    v_exp_f32_e64 v14, v14 clamp
    v_exp_f32_e64 v15, v15 clamp
    v_max_f32 v72, s79, v72
    v_max_f32 v73, s79, v73
    v_max_f32 v74, s79, v74
    v_max_f32 v75, s79, v75
    v_max_f32 v92, s79, v92
    v_max_f32 v93, s79, v93
    v_max_f32 v94, s79, v94
    v_max_f32 v95, s79, v95
    v_pk_add_f32 v[72:73], v[72:73], v[8:9]
    v_pk_add_f32 v[74:75], v[74:75], v[10:11]
    v_pk_add_f32 v[92:93], v[92:93], v[12:13]
    v_pk_add_f32 v[94:95], v[94:95], v[14:15]
    v_cvt_pk_bf16_f32 v32, v32, v33
    v_cvt_pk_bf16_f32 v33, v34, v35
    v_cvt_pk_bf16_f32 v34, v52, v53
    v_cvt_pk_bf16_f32 v35, v54, v55
    v_cvt_pk_bf16_f32 v72, v72, v73
    v_cvt_pk_bf16_f32 v73, v74, v75
    v_cvt_pk_bf16_f32 v74, v92, v93
    v_cvt_pk_bf16_f32 v75, v94, v95
    v_cvt_pk_bf16_f32 v40, v40, v41
    v_cvt_pk_bf16_f32 v41, v42, v43
    v_cvt_pk_bf16_f32 v42, v60, v61
    v_cvt_pk_bf16_f32 v43, v62, v63
    v_cvt_pk_bf16_f32 v80, v80, v81
    v_cvt_pk_bf16_f32 v81, v82, v83
    v_cvt_pk_bf16_f32 v82, v100, v101
    v_cvt_pk_bf16_f32 v83, v102, v103
    v_cvt_pk_bf16_f32 v44, v44, v45
    v_cvt_pk_bf16_f32 v45, v46, v47
    v_cvt_pk_bf16_f32 v46, v64, v65
    v_cvt_pk_bf16_f32 v47, v66, v67
    v_cvt_pk_bf16_f32 v84, v84, v85
    v_cvt_pk_bf16_f32 v85, v86, v87
    v_cvt_pk_bf16_f32 v86, v104, v105
    v_cvt_pk_bf16_f32 v87, v106, v107
    v_mfma_f32_16x16x32_bf16 v[120:123], v[32:35], v[40:43], 0
    v_mfma_f32_16x16x32_bf16 v[124:127], v[32:35], v[112:115], 0
    v_mfma_f32_16x16x32_bf16 v[128:131], v[48:51], v[40:43], 0
    v_mfma_f32_16x16x32_bf16 v[132:135], v[48:51], v[112:115], 0
    v_mfma_f32_16x16x32_bf16 v[144:147], v[48:51], v[44:47], 0
    v_mfma_f32_16x16x32_bf16 v[120:123], v[72:75], v[80:83], v[120:123]
    v_mfma_f32_16x16x32_bf16 v[124:127], v[72:75], v[116:119], v[124:127]
    v_mfma_f32_16x16x32_bf16 v[128:131], v[88:91], v[80:83], v[128:131]
    v_mfma_f32_16x16x32_bf16 v[132:135], v[88:91], v[116:119], v[132:135]
    v_mfma_f32_16x16x32_bf16 v[144:147], v[88:91], v[84:87], v[144:147]
    v_mul_f32 v8, s74, v36
    v_mul_f32 v9, s74, v37
    v_mul_f32 v10, s74, v38
    v_mul_f32 v11, s74, v39
    v_mul_f32 v12, s74, v56
    v_mul_f32 v13, s74, v57
    v_mul_f32 v14, s74, v58
    v_mul_f32 v15, s74, v59
    v_exp_f32_e64 v8, v8 clamp
    v_exp_f32_e64 v9, v9 clamp
    v_exp_f32_e64 v10, v10 clamp
    v_exp_f32_e64 v11, v11 clamp
    v_exp_f32_e64 v12, v12 clamp
    v_exp_f32_e64 v13, v13 clamp
    ds_write_b128 v16, v[120:123] offset:0
    v_exp_f32_e64 v14, v14 clamp
    v_exp_f32_e64 v15, v15 clamp
    v_max_f32 v36, s79, v36
    v_max_f32 v37, s79, v37
    v_max_f32 v38, s79, v38
    v_max_f32 v39, s79, v39
    v_max_f32 v56, s79, v56
    v_max_f32 v57, s79, v57
    s_mov_b32 exec_lo, 251727617
    s_mov_b32 exec_hi, 251727617
    ds_write_b128 v17, v[124:127] offset:0
    s_mov_b64 exec, -1
    v_max_f32 v58, s79, v58
    v_max_f32 v59, s79, v59
    v_add_f32 v36, v36, v8
    v_add_f32 v37, v37, v9
    v_add_f32 v38, v38, v10
    v_add_f32 v39, v39, v11
    v_add_f32 v56, v56, v12
    v_add_f32 v57, v57, v13
    s_mov_b32 exec_lo, 65535
    s_mov_b32 exec_hi, 0
    ds_write_b128 v16, v[128:131] offset:1344
    s_mov_b64 exec, -1
    v_add_f32 v58, v58, v14
    v_add_f32 v59, v59, v15
    v_pk_mul_f32 v[8:9], v[76:77], s[74:75]
    v_pk_mul_f32 v[10:11], v[78:79], s[74:75]
    v_pk_mul_f32 v[12:13], v[96:97], s[74:75]
    v_pk_mul_f32 v[14:15], v[98:99], s[74:75]
    v_exp_f32_e64 v8, v8 clamp
    v_exp_f32_e64 v9, v9 clamp
    s_mov_b32 exec_lo, 3841
    s_mov_b32 exec_hi, 0
    ds_write_b128 v17, v[132:135] offset:1344
    s_mov_b64 exec, -1
    v_exp_f32_e64 v10, v10 clamp
    v_exp_f32_e64 v11, v11 clamp
    v_exp_f32_e64 v12, v12 clamp
    v_exp_f32_e64 v13, v13 clamp
    v_exp_f32_e64 v14, v14 clamp
    v_exp_f32_e64 v15, v15 clamp
    v_max_f32 v76, s79, v76
    v_max_f32 v77, s79, v77
    s_mov_b32 exec_lo, 4026597376
    s_mov_b32 exec_hi, 0
    ds_write_b128 v17, v[132:135] offset:1456
    s_mov_b64 exec, -1
    v_max_f32 v78, s79, v78
    v_max_f32 v79, s79, v79
    v_max_f32 v96, s79, v96
    v_max_f32 v97, s79, v97
    v_max_f32 v98, s79, v98
    v_max_f32 v99, s79, v99
    v_pk_add_f32 v[76:77], v[76:77], v[8:9]
    v_pk_add_f32 v[78:79], v[78:79], v[10:11]
    s_mov_b32 exec_lo, 4294901760
    s_mov_b32 exec_hi, 0
    ds_write_b128 v16, v[144:147] offset:1520
    s_mov_b64 exec, -1
    v_pk_add_f32 v[96:97], v[96:97], v[12:13]
    v_pk_add_f32 v[98:99], v[98:99], v[14:15]
    v_cvt_pk_bf16_f32 v36, v36, v37
    v_cvt_pk_bf16_f32 v37, v38, v39
    v_cvt_pk_bf16_f32 v38, v56, v57
    v_cvt_pk_bf16_f32 v39, v58, v59
    v_cvt_pk_bf16_f32 v76, v76, v77
    v_cvt_pk_bf16_f32 v77, v78, v79
    v_cvt_pk_bf16_f32 v78, v96, v97
    v_cvt_pk_bf16_f32 v79, v98, v99
    v_mfma_f32_16x16x32_bf16 v[136:139], v[36:39], v[44:47], 0
    v_mfma_f32_16x16x32_bf16 v[140:143], v[36:39], v[112:115], 0
    v_mfma_f32_16x16x32_bf16 v[136:139], v[76:79], v[84:87], v[136:139]
    v_mfma_f32_16x16x32_bf16 v[140:143], v[76:79], v[116:119], v[140:143]
    s_nop 6
    ds_write_b128 v16, v[136:139] offset:2192
    s_mov_b32 exec_lo, 4026658817
    s_mov_b32 exec_hi, 4026658817
    ds_write_b128 v17, v[140:143] offset:2128
    s_mov_b64 exec, -1
    s_waitcnt lgkmcnt(0)
    s_barrier
    ds_read_b32 v32, v22 offset:0
    ds_read_b32 v40, v22 offset:7168
    ds_read_b32 v33, v22 offset:256
    ds_read_b32 v41, v22 offset:7424
    ds_read_b32 v34, v22 offset:512
    ds_read_b32 v42, v22 offset:7680
    ds_read_b32 v35, v22 offset:768
    ds_read_b32 v43, v22 offset:7936
    ds_read_b32 v36, v22 offset:1024
    ds_read_b32 v44, v22 offset:8192
    ds_read_b32 v37, v22 offset:1280
    ds_read_b32 v45, v22 offset:8448
    ds_read_b32 v38, v22 offset:1536
    ds_read_b32 v46, v22 offset:8704
    s_waitcnt lgkmcnt(12)
    v_add_f32 v32, v32, v40
    buffer_atomic_add_f32 v32, v21, s[44:47], s63 offen offset:0
    s_waitcnt lgkmcnt(10)
    v_add_f32 v33, v33, v41
    buffer_atomic_add_f32 v33, v21, s[44:47], s63 offen offset:256
    s_waitcnt lgkmcnt(8)
    v_add_f32 v34, v34, v42
    buffer_atomic_add_f32 v34, v21, s[44:47], s63 offen offset:512
    s_waitcnt lgkmcnt(6)
    v_add_f32 v35, v35, v43
    buffer_atomic_add_f32 v35, v21, s[44:47], s63 offen offset:768
    s_waitcnt lgkmcnt(4)
    v_add_f32 v36, v36, v44
    buffer_atomic_add_f32 v36, v21, s[44:47], s63 offen offset:1024
    s_waitcnt lgkmcnt(2)
    v_add_f32 v37, v37, v45
    buffer_atomic_add_f32 v37, v21, s[44:47], s63 offen offset:1280
    s_waitcnt lgkmcnt(0)
    v_add_f32 v38, v38, v46
    buffer_atomic_add_f32 v38, v21, s[44:47], s63 offen offset:1536
    v_mov_b32 v48, 81920
    v_mov_b32 v49, 1
    s_lshr_b32 s66, s52, 1
    s_lshl_b32 s68, s53, 4
    s_add_u32 s68, s68, s66
    s_and_b32 s66, s52, 1
    s_lshl_b32 s69, s54, 1
    s_add_u32 s69, s69, s66
    v_lshlrev_b32 v1, 4, v0
    v_mov_b32 v13, 0
    v_and_b32 v24, 31, v0
    v_lshrrev_b32 v25, 5, v0
    s_and_b32 s66, s50, 3
    s_lshl_b32 s67, s66, 6
    s_lshl_b32 s70, s66, 4
    s_add_u32 s70, s70, 256
    s_cmp_lt_u32 s50, 4
    s_cselect_b32 s67, s67, s70
    s_cselect_b32 s71, 4, 3
    v_mul_u32_u24 v14, 1280, v24
    v_lshl_add_u32 v14, v25, s71, v14
    s_mul_i32 s96, s68, 40960
    s_mul_i32 s70, s69, 320
    s_add_u32 s100, s96, 5242880
    s_add_u32 s96, s96, s70
    s_add_u32 s96, s96, s67
    s_lshl_b32 s71, s68, 7
    s_add_u32 s71, s71, 8962048
    v_lshlrev_b32 v19, 2, v24
    v_add_u32 v19, s71, v19
    v_bfe_u32 v26, v0, 2, 2
    v_lshl_add_u32 v26, v25, 2, v26
    v_lshlrev_b32 v17, 6, v26
    v_bfe_u32 v26, v0, 4, 1
    v_lshl_add_u32 v17, v26, 5, v17
    v_and_b32 v26, 3, v0
    v_lshl_add_u32 v17, v26, 3, v17
    s_lshl_b32 s67, s67, 5
    s_add_u32 s67, s67, 146176
    v_add_u32 v17, s67, v17
    s_lshl_b32 s67, s66, 12
    s_add_u32 s67, s67, 77824
    v_add_u32 v5, s67, v1
    s_lshl_b32 s67, s66, 10
    s_add_u32 s67, s67, 94208
    v_add_u32 v15, s67, v1
    s_mul_i32 s67, s66, 10240
    s_add_u32 s67, s67, 36864
    v_add_u32 v4, s67, v1
    v_add_u32 v3, 36864, v1
    s_mul_i32 s67, s50, 5120
    s_add_u32 s70, s67, 36864
    v_add_u32 v2, s70, v1
    s_add_u32 s97, s100, s67
    s_add_u32 s97, s97, 4292345856
    v_mul_u32_u24 v25, 336, v25
    v_min_u32 v26, 20, v24
    v_lshl_add_u32 v26, v26, 4, v25
    v_lshrrev_b32 v27, 2, v24
    v_mov_b32 v18, 0x7f000000
    v_cmp_eq_u32 vcc, 5, v27
    v_subrev_u32 v10, 4, v24
    v_lshl_add_u32 v10, v10, 4, v25
    v_cndmask_b32 v9, v26, v18, vcc
    v_cndmask_b32 v10, v26, v10, vcc
    v_cmp_eq_u32 vcc, 4, v27
    s_mul_i32 s98, s50, 7168
    s_add_u32 s98, s98, 8716288
    v_cndmask_b32 v10, v10, v18, vcc
    s_lshl_b32 s67, s50, 8
    s_add_u32 s67, s67, 8781824
    v_lshrrev_b32 v11, 5, v0
    v_lshlrev_b32 v11, 10, v11
    v_add_u32 v11, s67, v11
    v_mov_b32 v27, v11
    s_lshr_b32 s67, s68, 1
    s_lshl_b32 s67, s67, 3
    s_add_u32 s67, s67, s50
    s_lshl_b32 s67, s67, 8
    s_add_u32 s67, s67, 8798208
    v_writelane_b32 v11, s67, 0
    s_add_u32 s67, s67, 1024
    v_writelane_b32 v11, s67, 1
    s_lshr_b32 s67, s68, 3
    s_add_u32 s67, s67, 2
    s_bfe_u32 s67, s67, 0x10002
    s_mul_i32 s67, s67, 20
    s_mul_i32 s70, s69, 5
    s_add_u32 s67, s67, s70
    s_lshl_b32 s67, s67, 8
    s_add_u32 s67, s67, 8784896
    v_mov_b32 v12, s67
    s_lshl_b32 s71, s66, 8
    s_add_u32 s67, s67, s71
    s_sub_u32 s67, s67, 1024
    v_writelane_b32 v12, s67, 0
    s_lshl_b32 s70, s70, 11
    s_add_u32 s100, s100, s70
    s_lshl_b32 s101, s66, 11
    s_waitcnt vmcnt(0)
    s_mov_b64 exec, 1
    buffer_atomic_add v49, v48, s[44:47], s61 offen sc0 sc1
    s_mov_b64 exec, -1
    s_waitcnt vmcnt(0)
    v_readfirstlane_b32 s73, v49
    s_nop 0
    s_cmp_lg_u32 s73, 63
    s_cbranch_scc1 Lal_19
    v_mov_b32 v48, 0
    v_mov_b32 v49, s55
    s_mov_b64 exec, 1
    buffer_store_dword v49, v48, s[44:47], s61 offen sc1
    s_mov_b64 exec, -1
Lal_19:
    s_setprio 0
    s_branch Ls3
Lqa:
    s_mov_b32 s74, 0x3fb8aa3b
    s_mov_b32 s75, 0x3fb8aa3b
    s_mov_b32 s79, 0x358637bd
    s_mul_i32 s66, s54, 8
    s_lshl_b32 s76, s53, 4
    s_add_u32 s76, s76, s66
    s_add_u32 s76, s76, s52
    s_sub_u32 s76, s76, s51
    s_cmp_ge_u32 s50, 0
    s_cbranch_scc1 Lq1
    s_mov_b32 s99, s76
    s_add_u32 s65, s50, 10
    v_lshrrev_b32 v157, 3, v0
    v_and_b32 v158, 7, v0
    v_mul_u32_u24 v159, 5120, v157
    v_lshl_add_u32 v159, v158, 4, v159
    s_mul_i32 s66, s99, 40960
    s_lshl_b32 s67, s65, 7
    s_add_u32 s66, s66, s67
    v_add_u32 v220, s66, v159
    v_subrev_u32 v221, 3840, v220
    v_lshlrev_b32 v222, 6, v158
    s_lshl_b32 s67, s65, 9
    s_mov_b32 s18, 2621440
    s_mov_b32 s19, 0x20000
    s_mov_b32 s22, 2621440
    s_mov_b32 s23, 0x20000
    s_mov_b32 s26, 5120
    s_mov_b32 s27, 0x20000
    s_waitcnt lgkmcnt(0)
    buffer_load_dwordx4 v[172:175], v220, s[16:19], 0 offen offset:0
    buffer_load_dwordx4 v[176:179], v220, s[16:19], 0 offen offset:1280
    buffer_load_dwordx4 v[180:183], v220, s[16:19], 0 offen offset:2560
    buffer_load_dwordx4 v[184:187], v220, s[16:19], 0 offen offset:3840
    buffer_load_dwordx4 v[160:163], v221, s[16:19], 0 offen offset:0
    buffer_load_dwordx4 v[164:167], v221, s[16:19], 0 offen offset:1280
    buffer_load_dwordx4 v[168:171], v221, s[16:19], 0 offen offset:2560
    buffer_load_dwordx4 v[188:191], v220, s[20:23], 0 offen offset:0
    buffer_load_dwordx4 v[192:195], v220, s[20:23], 0 offen offset:1280
    buffer_load_dwordx4 v[196:199], v220, s[20:23], 0 offen offset:2560
    buffer_load_dwordx4 v[200:203], v220, s[20:23], 0 offen offset:3840
    buffer_load_dwordx4 v[204:207], v222, s[24:27], s67 offen offset:0
    buffer_load_dwordx4 v[208:211], v222, s[24:27], s67 offen offset:16
    buffer_load_dwordx4 v[212:215], v222, s[24:27], s67 offen offset:32
    buffer_load_dwordx4 v[216:219], v222, s[24:27], s67 offen offset:48
Lq1:
    s_mov_b32 s46, 9437184
    s_mov_b32 s47, 0x20000
    s_mov_b32 s42, 256
    s_mov_b32 s43, 0x20000
    s_mov_b32 s6, 2621440
    s_mov_b32 s7, 0x20000
    s_mov_b32 s38, 2621440
    s_mov_b32 s39, 0x20000
    v_mov_b32 v32, 0
    v_mov_b32 v33, 0
    v_mov_b32 v34, 0
    v_mov_b32 v35, 0
    v_mov_b32 v36, 0
    v_mov_b32 v37, 0
    v_mov_b32 v38, 0
    v_mov_b32 v39, 0
    v_mov_b32 v40, 0
    v_mov_b32 v41, 0
    v_mov_b32 v42, 0
    v_mov_b32 v43, 0
    v_mov_b32 v44, 0
    v_mov_b32 v45, 0
    v_mov_b32 v46, 0
    v_mov_b32 v47, 0
    v_mov_b32 v48, 0
    v_mov_b32 v49, 0
    v_mov_b32 v50, 0
    v_mov_b32 v51, 0
    v_mov_b32 v52, 0
    v_mov_b32 v53, 0
    v_mov_b32 v54, 0
    v_mov_b32 v55, 0
    v_mov_b32 v56, 0
    v_mov_b32 v57, 0
    v_mov_b32 v58, 0
    v_mov_b32 v59, 0
    v_mov_b32 v60, 0
    v_mov_b32 v61, 0
    v_mov_b32 v62, 0
    v_mov_b32 v63, 0
    v_mov_b32 v64, 0
    v_mov_b32 v65, 0
    v_mov_b32 v66, 0
    v_mov_b32 v67, 0
    v_mov_b32 v68, 0
    v_mov_b32 v69, 0
    v_mov_b32 v70, 0
    v_mov_b32 v71, 0
    v_mov_b32 v72, 0
    v_mov_b32 v73, 0
    v_mov_b32 v74, 0
    v_mov_b32 v75, 0
    v_mov_b32 v76, 0
    v_mov_b32 v77, 0
    v_mov_b32 v78, 0
    v_mov_b32 v79, 0
    v_mov_b32 v80, 0
    v_mov_b32 v81, 0
    v_mov_b32 v82, 0
    v_mov_b32 v83, 0
    v_mov_b32 v84, 0
    v_mov_b32 v85, 0
    v_mov_b32 v86, 0
    v_mov_b32 v87, 0
    v_mov_b32 v88, 0
    v_mov_b32 v89, 0
    v_mov_b32 v90, 0
    v_mov_b32 v91, 0
    v_mov_b32 v92, 0
    v_mov_b32 v93, 0
    v_mov_b32 v94, 0
    v_mov_b32 v95, 0
    v_mov_b32 v96, 0
    v_mov_b32 v97, 0
    v_mov_b32 v98, 0
    v_mov_b32 v99, 0
    v_mov_b32 v100, 0
    v_mov_b32 v101, 0
    v_mov_b32 v102, 0
    v_mov_b32 v103, 0
    v_mov_b32 v104, 0
    v_mov_b32 v105, 0
    v_mov_b32 v106, 0
    v_mov_b32 v107, 0
    v_mov_b32 v108, 0
    v_mov_b32 v109, 0
    v_mov_b32 v110, 0
    v_mov_b32 v111, 0
    s_bfe_u32 s66, s52, 0x20002
    s_mul_i32 s58, s54, 2
    s_add_u32 s58, s58, s66
    s_and_b32 s66, s50, 1
    s_lshr_b32 s67, s50, 1
    v_and_b32 v18, 15, v0
    v_lshrrev_b32 v19, 4, v0
    v_lshrrev_b32 v8, 1, v18
    v_xor_b32 v8, v19, v8
    v_lshlrev_b32 v8, 4, v8
    v_lshl_add_u32 v8, v18, 7, v8
    s_lshl_b32 s70, s67, 13
    v_add_u32 v148, s70, v8
    v_xor_b32 v149, 64, v148
    v_bfe_u32 v8, v0, 2, 2
    v_lshl_add_u32 v9, v19, 3, v8
    v_and_b32 v10, 1, v19
    v_xor_b32 v10, s66, v10
    v_and_b32 v11, 3, v0
    v_lshlrev_b32 v11, 3, v11
    v_lshl_add_u32 v154, v9, 6, v11
    v_lshl_add_u32 v154, v10, 5, v154
    v_add_u32 v154, 32768, v154
    v_lshl_or_b32 v8, v10, 2, v8
    v_lshl_add_u32 v8, v8, 5, v11
    v_lshl_add_u32 v8, v9, 8, v8
    v_add_u32 v150, 16384, v8
    v_xor_b32 v151, 32, v150
    v_xor_b32 v152, 64, v150
    v_xor_b32 v153, 96, v150
    v_lshrrev_b32 v8, 1, v19
    v_and_b32 v9, 1, v19
    v_lshlrev_b32 v20, 4, v18
    v_lshl_add_u32 v20, v9, 9, v20
    v_lshl_add_u32 v21, v8, 3, v20
    v_add_u32 v21, 4096, v21
    v_lshl_add_u32 v20, v8, 10, v20
    s_lshl_b32 s70, s57, 1
    s_add_u32 s70, s70, s67
    s_lshl_b32 s71, s58, 1
    s_add_u32 s71, s71, s66
    s_mul_i32 s66, s70, 81920
    s_mul_i32 s67, s71, 5120
    s_add_u32 s66, s66, s67
    s_add_u32 s63, s66, 2621440
    s_add_u32 s62, s63, 40960
    s_lshl_b32 s70, s70, 3
    s_add_u32 s70, s70, s71
    s_lshl_b32 s70, s70, 8
    s_add_u32 s61, s70, 8798208
    s_and_b32 s70, s52, 1
    s_lshl_b32 s71, s54, 1
    s_add_u32 s70, s70, s71
    s_lshl_b32 s70, s70, 3
    s_add_u32 s70, s70, s50
    s_mul_i32 s70, s70, 25600
    s_add_u32 s2, s70, 7864320
    v_lshlrev_b32 v28, 4, v0
    v_mov_b32 v24, 0
    s_cmp_ge_u32 s50, 0
    s_cbranch_scc1 Lq2
    s_mul_i32 s68, s50, 4608
    s_add_u32 s68, s68, 73728
    v_mul_u32_u24 v223, 576, v157
    v_lshl_add_u32 v223, v158, 4, v223
    v_add_u32 v223, s68, v223
    v_and_b32 v224, 15, v0
    v_mul_u32_u24 v225, 144, v224
    v_lshrrev_b32 v226, 4, v0
    v_lshl_add_u32 v225, v226, 3, v225
    v_add_u32 v225, s68, v225
    s_and_b32 s66, s99, 3
    v_xor_b32 v224, s66, v224
    v_lshlrev_b32 v224, 4, v224
    v_lshl_add_u32 v224, v226, 14, v224
    s_lshl_b32 s66, s65, 18
    s_lshl_b32 s67, s99, 8
    s_add_u32 s66, s66, s67
    s_mov_b32 s67, 0xffff0000
    s_waitcnt vmcnt(0)
    v_lshlrev_b32 v134, 16, v204
    v_and_b32 v136, s67, v204
    v_lshlrev_b32 v138, 16, v205
    v_and_b32 v140, s67, v205
    v_lshlrev_b32 v135, 16, v206
    v_and_b32 v137, s67, v206
    v_lshlrev_b32 v139, 16, v207
    v_and_b32 v141, s67, v207
    v_lshlrev_b32 v112, 16, v160
    v_and_b32 v113, s67, v160
    v_lshlrev_b32 v114, 16, v164
    v_and_b32 v115, s67, v164
    v_lshlrev_b32 v116, 16, v168
    v_and_b32 v117, s67, v168
    v_lshlrev_b32 v118, 16, v172
    v_and_b32 v119, s67, v172
    v_lshlrev_b32 v120, 16, v176
    v_and_b32 v121, s67, v176
    v_lshlrev_b32 v122, 16, v180
    v_and_b32 v123, s67, v180
    v_lshlrev_b32 v124, 16, v184
    v_and_b32 v125, s67, v184
    v_lshlrev_b32 v126, 16, v188
    v_and_b32 v127, s67, v188
    v_lshlrev_b32 v128, 16, v192
    v_and_b32 v129, s67, v192
    v_lshlrev_b32 v130, 16, v196
    v_and_b32 v131, s67, v196
    v_lshlrev_b32 v132, 16, v200
    v_and_b32 v133, s67, v200
    v_pk_mul_f32 v[244:245], v[118:119], v[134:135]
    v_pk_mul_f32 v[246:247], v[120:121], v[134:135]
    v_pk_mul_f32 v[248:249], v[122:123], v[134:135]
    v_pk_mul_f32 v[250:251], v[124:125], v[134:135]
    v_pk_fma_f32 v[244:245], v[116:117], v[136:137], v[244:245]
    v_pk_fma_f32 v[246:247], v[118:119], v[136:137], v[246:247]
    v_pk_fma_f32 v[248:249], v[120:121], v[136:137], v[248:249]
    v_pk_fma_f32 v[250:251], v[122:123], v[136:137], v[250:251]
    v_pk_fma_f32 v[244:245], v[114:115], v[138:139], v[244:245]
    v_pk_fma_f32 v[246:247], v[116:117], v[138:139], v[246:247]
    v_pk_fma_f32 v[248:249], v[118:119], v[138:139], v[248:249]
    v_pk_fma_f32 v[250:251], v[120:121], v[138:139], v[250:251]
    v_pk_fma_f32 v[244:245], v[112:113], v[140:141], v[244:245]
    v_pk_fma_f32 v[246:247], v[114:115], v[140:141], v[246:247]
    v_pk_fma_f32 v[248:249], v[116:117], v[140:141], v[248:249]
    v_pk_fma_f32 v[250:251], v[118:119], v[140:141], v[250:251]
    v_pk_mul_f32 v[244:245], v[244:245], v[126:127]
    v_pk_mul_f32 v[246:247], v[246:247], v[128:129]
    v_pk_mul_f32 v[248:249], v[248:249], v[130:131]
    v_pk_mul_f32 v[250:251], v[250:251], v[132:133]
    v_cvt_pk_bf16_f32 v228, v244, v245
    v_cvt_pk_bf16_f32 v232, v246, v247
    v_cvt_pk_bf16_f32 v236, v248, v249
    v_cvt_pk_bf16_f32 v240, v250, v251
    v_lshlrev_b32 v134, 16, v208
    v_and_b32 v136, s67, v208
    v_lshlrev_b32 v138, 16, v209
    v_and_b32 v140, s67, v209
    v_lshlrev_b32 v135, 16, v210
    v_and_b32 v137, s67, v210
    v_lshlrev_b32 v139, 16, v211
    v_and_b32 v141, s67, v211
    v_lshlrev_b32 v112, 16, v161
    v_and_b32 v113, s67, v161
    v_lshlrev_b32 v114, 16, v165
    v_and_b32 v115, s67, v165
    v_lshlrev_b32 v116, 16, v169
    v_and_b32 v117, s67, v169
    v_lshlrev_b32 v118, 16, v173
    v_and_b32 v119, s67, v173
    v_lshlrev_b32 v120, 16, v177
    v_and_b32 v121, s67, v177
    v_lshlrev_b32 v122, 16, v181
    v_and_b32 v123, s67, v181
    v_lshlrev_b32 v124, 16, v185
    v_and_b32 v125, s67, v185
    v_lshlrev_b32 v126, 16, v189
    v_and_b32 v127, s67, v189
    v_lshlrev_b32 v128, 16, v193
    v_and_b32 v129, s67, v193
    v_lshlrev_b32 v130, 16, v197
    v_and_b32 v131, s67, v197
    v_lshlrev_b32 v132, 16, v201
    v_and_b32 v133, s67, v201
    v_pk_mul_f32 v[244:245], v[118:119], v[134:135]
    v_pk_mul_f32 v[246:247], v[120:121], v[134:135]
    v_pk_mul_f32 v[248:249], v[122:123], v[134:135]
    v_pk_mul_f32 v[250:251], v[124:125], v[134:135]
    v_pk_fma_f32 v[244:245], v[116:117], v[136:137], v[244:245]
    v_pk_fma_f32 v[246:247], v[118:119], v[136:137], v[246:247]
    v_pk_fma_f32 v[248:249], v[120:121], v[136:137], v[248:249]
    v_pk_fma_f32 v[250:251], v[122:123], v[136:137], v[250:251]
    v_pk_fma_f32 v[244:245], v[114:115], v[138:139], v[244:245]
    v_pk_fma_f32 v[246:247], v[116:117], v[138:139], v[246:247]
    v_pk_fma_f32 v[248:249], v[118:119], v[138:139], v[248:249]
    v_pk_fma_f32 v[250:251], v[120:121], v[138:139], v[250:251]
    v_pk_fma_f32 v[244:245], v[112:113], v[140:141], v[244:245]
    v_pk_fma_f32 v[246:247], v[114:115], v[140:141], v[246:247]
    v_pk_fma_f32 v[248:249], v[116:117], v[140:141], v[248:249]
    v_pk_fma_f32 v[250:251], v[118:119], v[140:141], v[250:251]
    v_pk_mul_f32 v[244:245], v[244:245], v[126:127]
    v_pk_mul_f32 v[246:247], v[246:247], v[128:129]
    v_pk_mul_f32 v[248:249], v[248:249], v[130:131]
    v_pk_mul_f32 v[250:251], v[250:251], v[132:133]
    v_cvt_pk_bf16_f32 v229, v244, v245
    v_cvt_pk_bf16_f32 v233, v246, v247
    v_cvt_pk_bf16_f32 v237, v248, v249
    v_cvt_pk_bf16_f32 v241, v250, v251
    v_lshlrev_b32 v134, 16, v212
    v_and_b32 v136, s67, v212
    v_lshlrev_b32 v138, 16, v213
    v_and_b32 v140, s67, v213
    v_lshlrev_b32 v135, 16, v214
    v_and_b32 v137, s67, v214
    v_lshlrev_b32 v139, 16, v215
    v_and_b32 v141, s67, v215
    v_lshlrev_b32 v112, 16, v162
    v_and_b32 v113, s67, v162
    v_lshlrev_b32 v114, 16, v166
    v_and_b32 v115, s67, v166
    v_lshlrev_b32 v116, 16, v170
    v_and_b32 v117, s67, v170
    v_lshlrev_b32 v118, 16, v174
    v_and_b32 v119, s67, v174
    v_lshlrev_b32 v120, 16, v178
    v_and_b32 v121, s67, v178
    v_lshlrev_b32 v122, 16, v182
    v_and_b32 v123, s67, v182
    v_lshlrev_b32 v124, 16, v186
    v_and_b32 v125, s67, v186
    v_lshlrev_b32 v126, 16, v190
    v_and_b32 v127, s67, v190
    v_lshlrev_b32 v128, 16, v194
    v_and_b32 v129, s67, v194
    v_lshlrev_b32 v130, 16, v198
    v_and_b32 v131, s67, v198
    v_lshlrev_b32 v132, 16, v202
    v_and_b32 v133, s67, v202
    v_pk_mul_f32 v[244:245], v[118:119], v[134:135]
    v_pk_mul_f32 v[246:247], v[120:121], v[134:135]
    v_pk_mul_f32 v[248:249], v[122:123], v[134:135]
    v_pk_mul_f32 v[250:251], v[124:125], v[134:135]
    v_pk_fma_f32 v[244:245], v[116:117], v[136:137], v[244:245]
    v_pk_fma_f32 v[246:247], v[118:119], v[136:137], v[246:247]
    v_pk_fma_f32 v[248:249], v[120:121], v[136:137], v[248:249]
    v_pk_fma_f32 v[250:251], v[122:123], v[136:137], v[250:251]
    v_pk_fma_f32 v[244:245], v[114:115], v[138:139], v[244:245]
    v_pk_fma_f32 v[246:247], v[116:117], v[138:139], v[246:247]
    v_pk_fma_f32 v[248:249], v[118:119], v[138:139], v[248:249]
    v_pk_fma_f32 v[250:251], v[120:121], v[138:139], v[250:251]
    v_pk_fma_f32 v[244:245], v[112:113], v[140:141], v[244:245]
    v_pk_fma_f32 v[246:247], v[114:115], v[140:141], v[246:247]
    v_pk_fma_f32 v[248:249], v[116:117], v[140:141], v[248:249]
    v_pk_fma_f32 v[250:251], v[118:119], v[140:141], v[250:251]
    v_pk_mul_f32 v[244:245], v[244:245], v[126:127]
    v_pk_mul_f32 v[246:247], v[246:247], v[128:129]
    v_pk_mul_f32 v[248:249], v[248:249], v[130:131]
    v_pk_mul_f32 v[250:251], v[250:251], v[132:133]
    v_cvt_pk_bf16_f32 v230, v244, v245
    v_cvt_pk_bf16_f32 v234, v246, v247
    v_cvt_pk_bf16_f32 v238, v248, v249
    v_cvt_pk_bf16_f32 v242, v250, v251
    v_lshlrev_b32 v134, 16, v216
    v_and_b32 v136, s67, v216
    v_lshlrev_b32 v138, 16, v217
    v_and_b32 v140, s67, v217
    v_lshlrev_b32 v135, 16, v218
    v_and_b32 v137, s67, v218
    v_lshlrev_b32 v139, 16, v219
    v_and_b32 v141, s67, v219
    v_lshlrev_b32 v112, 16, v163
    v_and_b32 v113, s67, v163
    v_lshlrev_b32 v114, 16, v167
    v_and_b32 v115, s67, v167
    v_lshlrev_b32 v116, 16, v171
    v_and_b32 v117, s67, v171
    v_lshlrev_b32 v118, 16, v175
    v_and_b32 v119, s67, v175
    v_lshlrev_b32 v120, 16, v179
    v_and_b32 v121, s67, v179
    v_lshlrev_b32 v122, 16, v183
    v_and_b32 v123, s67, v183
    v_lshlrev_b32 v124, 16, v187
    v_and_b32 v125, s67, v187
    v_lshlrev_b32 v126, 16, v191
    v_and_b32 v127, s67, v191
    v_lshlrev_b32 v128, 16, v195
    v_and_b32 v129, s67, v195
    v_lshlrev_b32 v130, 16, v199
    v_and_b32 v131, s67, v199
    v_lshlrev_b32 v132, 16, v203
    v_and_b32 v133, s67, v203
    v_pk_mul_f32 v[244:245], v[118:119], v[134:135]
    v_pk_mul_f32 v[246:247], v[120:121], v[134:135]
    v_pk_mul_f32 v[248:249], v[122:123], v[134:135]
    v_pk_mul_f32 v[250:251], v[124:125], v[134:135]
    v_pk_fma_f32 v[244:245], v[116:117], v[136:137], v[244:245]
    v_pk_fma_f32 v[246:247], v[118:119], v[136:137], v[246:247]
    v_pk_fma_f32 v[248:249], v[120:121], v[136:137], v[248:249]
    v_pk_fma_f32 v[250:251], v[122:123], v[136:137], v[250:251]
    v_pk_fma_f32 v[244:245], v[114:115], v[138:139], v[244:245]
    v_pk_fma_f32 v[246:247], v[116:117], v[138:139], v[246:247]
    v_pk_fma_f32 v[248:249], v[118:119], v[138:139], v[248:249]
    v_pk_fma_f32 v[250:251], v[120:121], v[138:139], v[250:251]
    v_pk_fma_f32 v[244:245], v[112:113], v[140:141], v[244:245]
    v_pk_fma_f32 v[246:247], v[114:115], v[140:141], v[246:247]
    v_pk_fma_f32 v[248:249], v[116:117], v[140:141], v[248:249]
    v_pk_fma_f32 v[250:251], v[118:119], v[140:141], v[250:251]
    v_pk_mul_f32 v[244:245], v[244:245], v[126:127]
    v_pk_mul_f32 v[246:247], v[246:247], v[128:129]
    v_pk_mul_f32 v[248:249], v[248:249], v[130:131]
    v_pk_mul_f32 v[250:251], v[250:251], v[132:133]
    v_cvt_pk_bf16_f32 v231, v244, v245
    v_cvt_pk_bf16_f32 v235, v246, v247
    v_cvt_pk_bf16_f32 v239, v248, v249
    v_cvt_pk_bf16_f32 v243, v250, v251
    ds_write_b128 v223, v[228:231] offset:0
    ds_write_b128 v223, v[232:235] offset:144
    ds_write_b128 v223, v[236:239] offset:288
    ds_write_b128 v223, v[240:243] offset:432
    ds_read_b64_tr_b16 v[160:161], v225 offset:0
    ds_read_b64_tr_b16 v[162:163], v225 offset:2304
    ds_read_b64_tr_b16 v[164:165], v225 offset:32
    ds_read_b64_tr_b16 v[166:167], v225 offset:2336
    ds_read_b64_tr_b16 v[168:169], v225 offset:64
    ds_read_b64_tr_b16 v[170:171], v225 offset:2368
    ds_read_b64_tr_b16 v[172:173], v225 offset:96
    ds_read_b64_tr_b16 v[174:175], v225 offset:2400
    s_waitcnt lgkmcnt(6)
    buffer_store_dwordx4 v[160:163], v224, s[44:47], s66 offen sc1
    s_add_u32 s66, s66, 65536
    s_waitcnt lgkmcnt(4)
    buffer_store_dwordx4 v[164:167], v224, s[44:47], s66 offen sc1
    s_add_u32 s66, s66, 65536
    s_waitcnt lgkmcnt(2)
    buffer_store_dwordx4 v[168:171], v224, s[44:47], s66 offen sc1
    s_add_u32 s66, s66, 65536
    s_waitcnt lgkmcnt(0)
    buffer_store_dwordx4 v[172:175], v224, s[44:47], s66 offen sc1
Lq2:
    s_mov_b32 s68, 0
    s_mov_b32 s69, 0
    s_mov_b32 s72, 1024
    s_cmp_lt_u32 s50, 0
    s_cselect_b32 s72, 1034, s72
    s_waitcnt lgkmcnt(0)
    s_barrier
    ds_read_b128 v[112:115], v148 offset:0
    ds_read_b64_tr_b16 v[128:129], v150 offset:0
    ds_read_b64_tr_b16 v[130:131], v150 offset:1024
    ds_read_b128 v[116:119], v148 offset:2048
    ds_read_b64_tr_b16 v[132:133], v151 offset:0
    ds_read_b64_tr_b16 v[134:135], v151 offset:1024
    ds_read_b128 v[120:123], v148 offset:4096
    ds_read_b64_tr_b16 v[136:137], v152 offset:0
    ds_read_b64_tr_b16 v[138:139], v152 offset:1024
    ds_read_b128 v[124:127], v148 offset:6144
    ds_read_b64_tr_b16 v[140:141], v153 offset:0
    ds_read_b64_tr_b16 v[142:143], v153 offset:1024
    ds_read_b64_tr_b16 v[144:145], v154 offset:0
    ds_read_b64_tr_b16 v[146:147], v154 offset:256
.p2align 3
Lmlq:
    s_waitcnt lgkmcnt(0)
    v_mfma_f32_16x16x32_bf16 v[32:35], v[128:131], v[112:115], v[32:35]
    ds_read_b128 v[156:159], v149 offset:0
    v_mfma_f32_16x16x32_bf16 v[52:55], v[128:131], v[116:119], v[52:55]
    ds_read_b64_tr_b16 v[172:173], v150 offset:8192
    v_mfma_f32_16x16x32_bf16 v[72:75], v[128:131], v[120:123], v[72:75]
    ds_read_b64_tr_b16 v[174:175], v150 offset:9216
    s_add_u32 s69, s69, 1
    s_cmp_eq_u32 s69, 3
    v_mfma_f32_16x16x32_bf16 v[92:95], v[128:131], v[124:127], v[92:95]
    ds_read_b128 v[160:163], v149 offset:2048
    s_mov_b32 s70, 36864
    v_mfma_f32_16x16x32_bf16 v[36:39], v[132:135], v[112:115], v[36:39]
    ds_read_b64_tr_b16 v[176:177], v151 offset:8192
    s_cselect_b32 s70, 4294893568, s70
    v_mfma_f32_16x16x32_bf16 v[56:59], v[132:135], v[116:119], v[56:59]
    ds_read_b64_tr_b16 v[178:179], v151 offset:9216
    s_cselect_b32 s69, 0, s69
    s_add_u32 s68, s68, 1
    v_mfma_f32_16x16x32_bf16 v[76:79], v[132:135], v[120:123], v[76:79]
    ds_read_b128 v[164:167], v149 offset:4096
    v_mfma_f32_16x16x32_bf16 v[96:99], v[132:135], v[124:127], v[96:99]
    ds_read_b64_tr_b16 v[180:181], v152 offset:8192
    v_mfma_f32_16x16x32_bf16 v[40:43], v[136:139], v[112:115], v[40:43]
    ds_read_b64_tr_b16 v[182:183], v152 offset:9216
    v_mfma_f32_16x16x32_bf16 v[60:63], v[136:139], v[116:119], v[60:63]
    ds_read_b128 v[168:171], v149 offset:6144
    v_mfma_f32_16x16x32_bf16 v[80:83], v[136:139], v[120:123], v[80:83]
    ds_read_b64_tr_b16 v[184:185], v153 offset:8192
    v_mfma_f32_16x16x32_bf16 v[100:103], v[136:139], v[124:127], v[100:103]
    ds_read_b64_tr_b16 v[186:187], v153 offset:9216
    v_mfma_f32_16x16x32_bf16 v[44:47], v[140:143], v[112:115], v[44:47]
    ds_read_b64_tr_b16 v[188:189], v154 offset:2048
    v_mfma_f32_16x16x32_bf16 v[64:67], v[140:143], v[116:119], v[64:67]
    ds_read_b64_tr_b16 v[190:191], v154 offset:2304
    v_mfma_f32_16x16x32_bf16 v[84:87], v[140:143], v[120:123], v[84:87]
    v_add_u32 v148, s70, v148
    v_add_u32 v149, s70, v149
    v_mfma_f32_16x16x32_bf16 v[104:107], v[140:143], v[124:127], v[104:107]
    v_add_u32 v150, s70, v150
    v_add_u32 v151, s70, v151
    v_mfma_f32_16x16x32_bf16 v[48:51], v[144:147], v[112:115], v[48:51]
    v_add_u32 v152, s70, v152
    v_add_u32 v153, s70, v153
    v_mfma_f32_16x16x32_bf16 v[68:71], v[144:147], v[116:119], v[68:71]
    v_add_u32 v154, s70, v154
    s_bitcmp1_b32 s72, s68
    v_mfma_f32_16x16x32_bf16 v[88:91], v[144:147], v[120:123], v[88:91]
    v_mfma_f32_16x16x32_bf16 v[108:111], v[144:147], v[124:127], v[108:111]
    s_waitcnt lgkmcnt(0)
    s_cbranch_scc1 Lhookq
Lhookdq:
    s_barrier
    v_mfma_f32_16x16x32_bf16 v[32:35], v[172:175], v[156:159], v[32:35]
    ds_read_b128 v[112:115], v148 offset:0
    v_mfma_f32_16x16x32_bf16 v[52:55], v[172:175], v[160:163], v[52:55]
    ds_read_b64_tr_b16 v[128:129], v150 offset:0
    v_mfma_f32_16x16x32_bf16 v[72:75], v[172:175], v[164:167], v[72:75]
    ds_read_b64_tr_b16 v[130:131], v150 offset:1024
    v_mfma_f32_16x16x32_bf16 v[92:95], v[172:175], v[168:171], v[92:95]
    ds_read_b128 v[116:119], v148 offset:2048
    v_mfma_f32_16x16x32_bf16 v[36:39], v[176:179], v[156:159], v[36:39]
    ds_read_b64_tr_b16 v[132:133], v151 offset:0
    v_mfma_f32_16x16x32_bf16 v[56:59], v[176:179], v[160:163], v[56:59]
    ds_read_b64_tr_b16 v[134:135], v151 offset:1024
    v_mfma_f32_16x16x32_bf16 v[76:79], v[176:179], v[164:167], v[76:79]
    ds_read_b128 v[120:123], v148 offset:4096
    v_mfma_f32_16x16x32_bf16 v[96:99], v[176:179], v[168:171], v[96:99]
    ds_read_b64_tr_b16 v[136:137], v152 offset:0
    v_mfma_f32_16x16x32_bf16 v[40:43], v[180:183], v[156:159], v[40:43]
    ds_read_b64_tr_b16 v[138:139], v152 offset:1024
    v_mfma_f32_16x16x32_bf16 v[60:63], v[180:183], v[160:163], v[60:63]
    ds_read_b128 v[124:127], v148 offset:6144
    v_mfma_f32_16x16x32_bf16 v[80:83], v[180:183], v[164:167], v[80:83]
    ds_read_b64_tr_b16 v[140:141], v153 offset:0
    v_mfma_f32_16x16x32_bf16 v[100:103], v[180:183], v[168:171], v[100:103]
    ds_read_b64_tr_b16 v[142:143], v153 offset:1024
    v_mfma_f32_16x16x32_bf16 v[44:47], v[184:187], v[156:159], v[44:47]
    ds_read_b64_tr_b16 v[144:145], v154 offset:0
    v_mfma_f32_16x16x32_bf16 v[64:67], v[184:187], v[160:163], v[64:67]
    ds_read_b64_tr_b16 v[146:147], v154 offset:256
    v_mfma_f32_16x16x32_bf16 v[84:87], v[184:187], v[164:167], v[84:87]
    v_mfma_f32_16x16x32_bf16 v[104:107], v[184:187], v[168:171], v[104:107]
    v_mfma_f32_16x16x32_bf16 v[48:51], v[188:191], v[156:159], v[48:51]
    v_mfma_f32_16x16x32_bf16 v[68:71], v[188:191], v[160:163], v[68:71]
    v_mfma_f32_16x16x32_bf16 v[88:91], v[188:191], v[164:167], v[88:91]
    v_mfma_f32_16x16x32_bf16 v[108:111], v[188:191], v[168:171], v[108:111]
    s_branch Lmlq
Lhookq:
    s_cmp_eq_u32 s68, 10
    s_cbranch_scc1 Lmxq
    s_cmp_lg_u32 s68, 1
    s_cbranch_scc1 Lhk_20
    s_waitcnt vmcnt(0)
    v_mov_b32 v25, 1
    s_mov_b64 exec, 1
    buffer_atomic_add v25, v24, s[40:43], 0 offen offset:0 sc0 sc1
    s_mov_b64 exec, -1
    s_branch Lhookdq
Lhk_20:
    s_waitcnt vmcnt(0)
    v_readfirstlane_b32 s73, v25
    s_nop 0
    s_cmp_lg_u32 s73, 63
    s_cbranch_scc1 Lda_21
    v_mov_b32 v25, 1
    s_mov_b64 exec, 1
    buffer_store_dword v25, v24, s[40:43], 0 offen offset:128 sc1
    s_mov_b64 exec, -1
Lda_21:
    s_branch Lhookdq
Lmxq:
    v_mfma_f32_16x16x32_bf16 v[32:35], v[172:175], v[156:159], v[32:35]
    v_mfma_f32_16x16x32_bf16 v[36:39], v[176:179], v[156:159], v[36:39]
    v_mfma_f32_16x16x32_bf16 v[40:43], v[180:183], v[156:159], v[40:43]
    v_mfma_f32_16x16x32_bf16 v[44:47], v[184:187], v[156:159], v[44:47]
    v_mfma_f32_16x16x32_bf16 v[48:51], v[188:191], v[156:159], v[48:51]
    v_mfma_f32_16x16x32_bf16 v[52:55], v[172:175], v[160:163], v[52:55]
    v_mfma_f32_16x16x32_bf16 v[56:59], v[176:179], v[160:163], v[56:59]
    v_mfma_f32_16x16x32_bf16 v[60:63], v[180:183], v[160:163], v[60:63]
    v_mfma_f32_16x16x32_bf16 v[64:67], v[184:187], v[160:163], v[64:67]
    v_mfma_f32_16x16x32_bf16 v[68:71], v[188:191], v[160:163], v[68:71]
    v_mul_f32 v112, s74, v32
    v_mul_f32 v113, s74, v33
    v_mfma_f32_16x16x32_bf16 v[72:75], v[172:175], v[164:167], v[72:75]
    v_mul_f32 v114, s74, v34
    v_mul_f32 v115, s74, v35
    v_mfma_f32_16x16x32_bf16 v[76:79], v[176:179], v[164:167], v[76:79]
    v_mul_f32 v116, s74, v36
    v_mul_f32 v117, s74, v37
    v_mfma_f32_16x16x32_bf16 v[80:83], v[180:183], v[164:167], v[80:83]
    v_mul_f32 v118, s74, v38
    v_mul_f32 v119, s74, v39
    v_mfma_f32_16x16x32_bf16 v[84:87], v[184:187], v[164:167], v[84:87]
    v_exp_f32_e64 v112, v112 clamp
    v_exp_f32_e64 v113, v113 clamp
    v_mfma_f32_16x16x32_bf16 v[88:91], v[188:191], v[164:167], v[88:91]
    v_exp_f32_e64 v114, v114 clamp
    v_exp_f32_e64 v115, v115 clamp
    v_mfma_f32_16x16x32_bf16 v[92:95], v[172:175], v[168:171], v[92:95]
    v_exp_f32_e64 v116, v116 clamp
    v_exp_f32_e64 v117, v117 clamp
    v_mfma_f32_16x16x32_bf16 v[96:99], v[176:179], v[168:171], v[96:99]
    v_exp_f32_e64 v118, v118 clamp
    v_exp_f32_e64 v119, v119 clamp
    v_mfma_f32_16x16x32_bf16 v[100:103], v[180:183], v[168:171], v[100:103]
    v_max_f32 v32, s79, v32
    v_max_f32 v33, s79, v33
    v_mfma_f32_16x16x32_bf16 v[104:107], v[184:187], v[168:171], v[104:107]
    v_max_f32 v34, s79, v34
    v_max_f32 v35, s79, v35
    v_mfma_f32_16x16x32_bf16 v[108:111], v[188:191], v[168:171], v[108:111]
    v_max_f32 v36, s79, v36
    v_max_f32 v37, s79, v37
    v_max_f32 v38, s79, v38
    v_max_f32 v39, s79, v39
    v_add_f32 v32, v32, v112
    v_add_f32 v33, v33, v113
    v_add_f32 v34, v34, v114
    v_add_f32 v35, v35, v115
    v_add_f32 v36, v36, v116
    v_add_f32 v37, v37, v117
    v_add_f32 v38, v38, v118
    v_add_f32 v39, v39, v119
    v_mul_f32 v112, s74, v40
    v_mul_f32 v113, s74, v41
    v_mul_f32 v114, s74, v42
    v_mul_f32 v115, s74, v43
    v_mul_f32 v116, s74, v44
    v_mul_f32 v117, s74, v45
    v_mul_f32 v118, s74, v46
    v_mul_f32 v119, s74, v47
    v_exp_f32_e64 v112, v112 clamp
    v_exp_f32_e64 v113, v113 clamp
    v_exp_f32_e64 v114, v114 clamp
    v_exp_f32_e64 v115, v115 clamp
    v_exp_f32_e64 v116, v116 clamp
    v_exp_f32_e64 v117, v117 clamp
    v_exp_f32_e64 v118, v118 clamp
    v_exp_f32_e64 v119, v119 clamp
    v_max_f32 v40, s79, v40
    v_max_f32 v41, s79, v41
    v_max_f32 v42, s79, v42
    v_max_f32 v43, s79, v43
    v_max_f32 v44, s79, v44
    v_max_f32 v45, s79, v45
    v_max_f32 v46, s79, v46
    v_max_f32 v47, s79, v47
    v_add_f32 v40, v40, v112
    v_add_f32 v41, v41, v113
    v_add_f32 v42, v42, v114
    v_add_f32 v43, v43, v115
    v_add_f32 v44, v44, v116
    v_add_f32 v45, v45, v117
    v_add_f32 v46, v46, v118
    v_add_f32 v47, v47, v119
    v_mul_f32 v112, s74, v48
    v_mul_f32 v113, s74, v49
    v_mul_f32 v114, s74, v50
    v_mul_f32 v115, s74, v51
    v_exp_f32_e64 v112, v112 clamp
    v_exp_f32_e64 v113, v113 clamp
    v_exp_f32_e64 v114, v114 clamp
    v_exp_f32_e64 v115, v115 clamp
    v_max_f32 v48, s79, v48
    v_max_f32 v49, s79, v49
    v_max_f32 v50, s79, v50
    v_max_f32 v51, s79, v51
    v_add_f32 v48, v48, v112
    v_add_f32 v49, v49, v113
    v_add_f32 v50, v50, v114
    v_add_f32 v51, v51, v115
    v_cvt_pk_bf16_f32 v32, v32, v33
    v_cvt_pk_bf16_f32 v33, v34, v35
    v_cvt_pk_bf16_f32 v34, v36, v37
    v_cvt_pk_bf16_f32 v35, v38, v39
    v_cvt_pk_bf16_f32 v36, v40, v41
    v_cvt_pk_bf16_f32 v37, v42, v43
    v_cvt_pk_bf16_f32 v38, v44, v45
    v_cvt_pk_bf16_f32 v39, v46, v47
    v_cvt_pk_bf16_f32 v40, v48, v49
    v_cvt_pk_bf16_f32 v41, v50, v51
    buffer_store_dwordx4 v[32:35], v20, s[44:47], s63 offen offset:0 sc1
    buffer_store_dwordx4 v[36:39], v20, s[44:47], s63 offen offset:2048 sc1
    buffer_store_dwordx2 v[40:41], v21, s[44:47], s63 offen offset:0 sc1
    v_pk_mul_f32 v[112:113], v[52:53], s[74:75]
    v_pk_mul_f32 v[114:115], v[54:55], s[74:75]
    v_pk_mul_f32 v[116:117], v[56:57], s[74:75]
    v_pk_mul_f32 v[118:119], v[58:59], s[74:75]
    v_exp_f32_e64 v112, v112 clamp
    v_exp_f32_e64 v113, v113 clamp
    v_exp_f32_e64 v114, v114 clamp
    v_exp_f32_e64 v115, v115 clamp
    v_exp_f32_e64 v116, v116 clamp
    v_exp_f32_e64 v117, v117 clamp
    v_exp_f32_e64 v118, v118 clamp
    v_exp_f32_e64 v119, v119 clamp
    v_max_f32 v52, s79, v52
    v_max_f32 v53, s79, v53
    v_max_f32 v54, s79, v54
    v_max_f32 v55, s79, v55
    v_max_f32 v56, s79, v56
    v_max_f32 v57, s79, v57
    v_max_f32 v58, s79, v58
    v_max_f32 v59, s79, v59
    v_pk_add_f32 v[52:53], v[52:53], v[112:113]
    v_pk_add_f32 v[54:55], v[54:55], v[114:115]
    v_pk_add_f32 v[56:57], v[56:57], v[116:117]
    v_pk_add_f32 v[58:59], v[58:59], v[118:119]
    v_pk_mul_f32 v[112:113], v[60:61], s[74:75]
    v_pk_mul_f32 v[114:115], v[62:63], s[74:75]
    v_pk_mul_f32 v[116:117], v[64:65], s[74:75]
    v_pk_mul_f32 v[118:119], v[66:67], s[74:75]
    v_exp_f32_e64 v112, v112 clamp
    v_exp_f32_e64 v113, v113 clamp
    v_exp_f32_e64 v114, v114 clamp
    v_exp_f32_e64 v115, v115 clamp
    v_exp_f32_e64 v116, v116 clamp
    v_exp_f32_e64 v117, v117 clamp
    v_exp_f32_e64 v118, v118 clamp
    v_exp_f32_e64 v119, v119 clamp
    v_max_f32 v60, s79, v60
    v_max_f32 v61, s79, v61
    v_max_f32 v62, s79, v62
    v_max_f32 v63, s79, v63
    v_max_f32 v64, s79, v64
    v_max_f32 v65, s79, v65
    v_max_f32 v66, s79, v66
    v_max_f32 v67, s79, v67
    v_pk_add_f32 v[60:61], v[60:61], v[112:113]
    v_pk_add_f32 v[62:63], v[62:63], v[114:115]
    v_pk_add_f32 v[64:65], v[64:65], v[116:117]
    v_pk_add_f32 v[66:67], v[66:67], v[118:119]
    v_pk_mul_f32 v[112:113], v[68:69], s[74:75]
    v_pk_mul_f32 v[114:115], v[70:71], s[74:75]
    v_exp_f32_e64 v112, v112 clamp
    v_exp_f32_e64 v113, v113 clamp
    v_exp_f32_e64 v114, v114 clamp
    v_exp_f32_e64 v115, v115 clamp
    v_max_f32 v68, s79, v68
    v_max_f32 v69, s79, v69
    v_max_f32 v70, s79, v70
    v_max_f32 v71, s79, v71
    v_pk_add_f32 v[68:69], v[68:69], v[112:113]
    v_pk_add_f32 v[70:71], v[70:71], v[114:115]
    v_cvt_pk_bf16_f32 v52, v52, v53
    v_cvt_pk_bf16_f32 v53, v54, v55
    v_cvt_pk_bf16_f32 v54, v56, v57
    v_cvt_pk_bf16_f32 v55, v58, v59
    v_cvt_pk_bf16_f32 v56, v60, v61
    v_cvt_pk_bf16_f32 v57, v62, v63
    v_cvt_pk_bf16_f32 v58, v64, v65
    v_cvt_pk_bf16_f32 v59, v66, v67
    v_cvt_pk_bf16_f32 v60, v68, v69
    v_cvt_pk_bf16_f32 v61, v70, v71
    buffer_store_dwordx4 v[52:55], v20, s[44:47], s63 offen offset:256 sc1
    buffer_store_dwordx4 v[56:59], v20, s[44:47], s63 offen offset:2304 sc1
    buffer_store_dwordx2 v[60:61], v21, s[44:47], s63 offen offset:256 sc1
    v_pk_mul_f32 v[112:113], v[72:73], s[74:75]
    v_pk_mul_f32 v[114:115], v[74:75], s[74:75]
    v_pk_mul_f32 v[116:117], v[76:77], s[74:75]
    v_pk_mul_f32 v[118:119], v[78:79], s[74:75]
    v_exp_f32_e64 v112, v112 clamp
    v_exp_f32_e64 v113, v113 clamp
    v_exp_f32_e64 v114, v114 clamp
    v_exp_f32_e64 v115, v115 clamp
    v_exp_f32_e64 v116, v116 clamp
    v_exp_f32_e64 v117, v117 clamp
    v_exp_f32_e64 v118, v118 clamp
    v_exp_f32_e64 v119, v119 clamp
    v_max_f32 v72, s79, v72
    v_max_f32 v73, s79, v73
    v_max_f32 v74, s79, v74
    v_max_f32 v75, s79, v75
    v_max_f32 v76, s79, v76
    v_max_f32 v77, s79, v77
    v_max_f32 v78, s79, v78
    v_max_f32 v79, s79, v79
    v_pk_add_f32 v[72:73], v[72:73], v[112:113]
    v_pk_add_f32 v[74:75], v[74:75], v[114:115]
    v_pk_add_f32 v[76:77], v[76:77], v[116:117]
    v_pk_add_f32 v[78:79], v[78:79], v[118:119]
    v_pk_mul_f32 v[112:113], v[80:81], s[74:75]
    v_pk_mul_f32 v[114:115], v[82:83], s[74:75]
    v_pk_mul_f32 v[116:117], v[84:85], s[74:75]
    v_pk_mul_f32 v[118:119], v[86:87], s[74:75]
    v_exp_f32_e64 v112, v112 clamp
    v_exp_f32_e64 v113, v113 clamp
    v_exp_f32_e64 v114, v114 clamp
    v_exp_f32_e64 v115, v115 clamp
    v_exp_f32_e64 v116, v116 clamp
    v_exp_f32_e64 v117, v117 clamp
    v_exp_f32_e64 v118, v118 clamp
    v_exp_f32_e64 v119, v119 clamp
    v_max_f32 v80, s79, v80
    v_max_f32 v81, s79, v81
    v_max_f32 v82, s79, v82
    v_max_f32 v83, s79, v83
    v_max_f32 v84, s79, v84
    v_max_f32 v85, s79, v85
    v_max_f32 v86, s79, v86
    v_max_f32 v87, s79, v87
    v_pk_add_f32 v[80:81], v[80:81], v[112:113]
    v_pk_add_f32 v[82:83], v[82:83], v[114:115]
    v_pk_add_f32 v[84:85], v[84:85], v[116:117]
    v_pk_add_f32 v[86:87], v[86:87], v[118:119]
    v_pk_mul_f32 v[112:113], v[88:89], s[74:75]
    v_pk_mul_f32 v[114:115], v[90:91], s[74:75]
    v_exp_f32_e64 v112, v112 clamp
    v_exp_f32_e64 v113, v113 clamp
    v_exp_f32_e64 v114, v114 clamp
    v_exp_f32_e64 v115, v115 clamp
    v_max_f32 v88, s79, v88
    v_max_f32 v89, s79, v89
    v_max_f32 v90, s79, v90
    v_max_f32 v91, s79, v91
    v_pk_add_f32 v[88:89], v[88:89], v[112:113]
    v_pk_add_f32 v[90:91], v[90:91], v[114:115]
    v_cvt_pk_bf16_f32 v72, v72, v73
    v_cvt_pk_bf16_f32 v73, v74, v75
    v_cvt_pk_bf16_f32 v74, v76, v77
    v_cvt_pk_bf16_f32 v75, v78, v79
    v_cvt_pk_bf16_f32 v76, v80, v81
    v_cvt_pk_bf16_f32 v77, v82, v83
    v_cvt_pk_bf16_f32 v78, v84, v85
    v_cvt_pk_bf16_f32 v79, v86, v87
    v_cvt_pk_bf16_f32 v80, v88, v89
    v_cvt_pk_bf16_f32 v81, v90, v91
    buffer_store_dwordx4 v[72:75], v20, s[44:47], s62 offen offset:0 sc1
    buffer_store_dwordx4 v[76:79], v20, s[44:47], s62 offen offset:2048 sc1
    buffer_store_dwordx2 v[80:81], v21, s[44:47], s62 offen offset:0 sc1
    v_pk_mul_f32 v[112:113], v[92:93], s[74:75]
    v_pk_mul_f32 v[114:115], v[94:95], s[74:75]
    v_pk_mul_f32 v[116:117], v[96:97], s[74:75]
    v_pk_mul_f32 v[118:119], v[98:99], s[74:75]
    v_exp_f32_e64 v112, v112 clamp
    v_exp_f32_e64 v113, v113 clamp
    v_exp_f32_e64 v114, v114 clamp
    v_exp_f32_e64 v115, v115 clamp
    v_exp_f32_e64 v116, v116 clamp
    v_exp_f32_e64 v117, v117 clamp
    v_exp_f32_e64 v118, v118 clamp
    v_exp_f32_e64 v119, v119 clamp
    v_max_f32 v92, s79, v92
    v_max_f32 v93, s79, v93
    v_max_f32 v94, s79, v94
    v_max_f32 v95, s79, v95
    v_max_f32 v96, s79, v96
    v_max_f32 v97, s79, v97
    v_max_f32 v98, s79, v98
    v_max_f32 v99, s79, v99
    v_pk_add_f32 v[92:93], v[92:93], v[112:113]
    v_pk_add_f32 v[94:95], v[94:95], v[114:115]
    v_pk_add_f32 v[96:97], v[96:97], v[116:117]
    v_pk_add_f32 v[98:99], v[98:99], v[118:119]
    v_pk_mul_f32 v[112:113], v[100:101], s[74:75]
    v_pk_mul_f32 v[114:115], v[102:103], s[74:75]
    v_pk_mul_f32 v[116:117], v[104:105], s[74:75]
    v_pk_mul_f32 v[118:119], v[106:107], s[74:75]
    v_exp_f32_e64 v112, v112 clamp
    v_exp_f32_e64 v113, v113 clamp
    v_exp_f32_e64 v114, v114 clamp
    v_exp_f32_e64 v115, v115 clamp
    v_exp_f32_e64 v116, v116 clamp
    v_exp_f32_e64 v117, v117 clamp
    v_exp_f32_e64 v118, v118 clamp
    v_exp_f32_e64 v119, v119 clamp
    v_max_f32 v100, s79, v100
    v_max_f32 v101, s79, v101
    v_max_f32 v102, s79, v102
    v_max_f32 v103, s79, v103
    v_max_f32 v104, s79, v104
    v_max_f32 v105, s79, v105
    v_max_f32 v106, s79, v106
    v_max_f32 v107, s79, v107
    v_pk_add_f32 v[100:101], v[100:101], v[112:113]
    v_pk_add_f32 v[102:103], v[102:103], v[114:115]
    v_pk_add_f32 v[104:105], v[104:105], v[116:117]
    v_pk_add_f32 v[106:107], v[106:107], v[118:119]
    v_pk_mul_f32 v[112:113], v[108:109], s[74:75]
    v_pk_mul_f32 v[114:115], v[110:111], s[74:75]
    v_exp_f32_e64 v112, v112 clamp
    v_exp_f32_e64 v113, v113 clamp
    v_exp_f32_e64 v114, v114 clamp
    v_exp_f32_e64 v115, v115 clamp
    v_max_f32 v108, s79, v108
    v_max_f32 v109, s79, v109
    v_max_f32 v110, s79, v110
    v_max_f32 v111, s79, v111
    v_pk_add_f32 v[108:109], v[108:109], v[112:113]
    v_pk_add_f32 v[110:111], v[110:111], v[114:115]
    v_cvt_pk_bf16_f32 v92, v92, v93
    v_cvt_pk_bf16_f32 v93, v94, v95
    v_cvt_pk_bf16_f32 v94, v96, v97
    v_cvt_pk_bf16_f32 v95, v98, v99
    v_cvt_pk_bf16_f32 v96, v100, v101
    v_cvt_pk_bf16_f32 v97, v102, v103
    v_cvt_pk_bf16_f32 v98, v104, v105
    v_cvt_pk_bf16_f32 v99, v106, v107
    v_cvt_pk_bf16_f32 v100, v108, v109
    v_cvt_pk_bf16_f32 v101, v110, v111
    buffer_store_dwordx4 v[92:95], v20, s[44:47], s62 offen offset:256 sc1
    buffer_store_dwordx4 v[96:99], v20, s[44:47], s62 offen offset:2304 sc1
    buffer_store_dwordx2 v[100:101], v21, s[44:47], s62 offen offset:256 sc1
    v_mov_b32 v122, 146048
    s_mov_b32 s56, 0x400000
Lls_22:
    ds_read_b32 v123, v122
    s_waitcnt lgkmcnt(0)
    v_readfirstlane_b32 s73, v123
    s_nop 0
    s_cmp_ge_u32 s73, 4
    s_cbranch_scc1 Lld_23
    s_sub_u32 s56, s56, 1
    s_cbranch_scc0 Lls_22
Lld_23:
    s_waitcnt vmcnt(0)
    v_mov_b32 v120, 0
    v_mov_b32 v121, s55
    s_mov_b64 exec, 1
    buffer_store_dword v121, v120, s[44:47], s61 offen sc1
    s_mov_b64 exec, -1
    s_barrier
    s_lshr_b32 s66, s52, 1
    s_lshl_b32 s68, s53, 4
    s_add_u32 s68, s68, s66
    s_and_b32 s66, s52, 1
    s_lshl_b32 s69, s54, 1
    s_add_u32 s69, s69, s66
    v_lshlrev_b32 v1, 4, v0
    v_mov_b32 v13, 0
    v_and_b32 v24, 31, v0
    v_lshrrev_b32 v25, 5, v0
    s_and_b32 s66, s50, 3
    s_lshl_b32 s67, s66, 6
    s_lshl_b32 s70, s66, 4
    s_add_u32 s70, s70, 256
    s_cmp_lt_u32 s50, 4
    s_cselect_b32 s67, s67, s70
    s_cselect_b32 s71, 4, 3
    v_mul_u32_u24 v14, 1280, v24
    v_lshl_add_u32 v14, v25, s71, v14
    s_mul_i32 s96, s68, 40960
    s_mul_i32 s70, s69, 320
    s_add_u32 s100, s96, 5242880
    s_add_u32 s96, s96, s70
    s_add_u32 s96, s96, s67
    s_lshl_b32 s71, s68, 7
    s_add_u32 s71, s71, 8962048
    v_lshlrev_b32 v19, 2, v24
    v_add_u32 v19, s71, v19
    v_bfe_u32 v26, v0, 2, 2
    v_lshl_add_u32 v26, v25, 2, v26
    v_lshlrev_b32 v17, 6, v26
    v_bfe_u32 v26, v0, 4, 1
    v_lshl_add_u32 v17, v26, 5, v17
    v_and_b32 v26, 3, v0
    v_lshl_add_u32 v17, v26, 3, v17
    s_lshl_b32 s67, s67, 5
    s_add_u32 s67, s67, 146176
    v_add_u32 v17, s67, v17
    s_lshl_b32 s67, s66, 12
    s_add_u32 s67, s67, 77824
    v_add_u32 v5, s67, v1
    s_lshl_b32 s67, s66, 10
    s_add_u32 s67, s67, 94208
    v_add_u32 v15, s67, v1
    s_mul_i32 s67, s66, 10240
    s_add_u32 s67, s67, 36864
    v_add_u32 v4, s67, v1
    v_add_u32 v3, 36864, v1
    s_mul_i32 s67, s50, 5120
    s_add_u32 s70, s67, 36864
    v_add_u32 v2, s70, v1
    s_add_u32 s97, s100, s67
    s_add_u32 s97, s97, 4292345856
    v_mul_u32_u24 v25, 336, v25
    v_min_u32 v26, 20, v24
    v_lshl_add_u32 v26, v26, 4, v25
    v_lshrrev_b32 v27, 2, v24
    v_mov_b32 v18, 0x7f000000
    v_cmp_eq_u32 vcc, 5, v27
    v_subrev_u32 v10, 4, v24
    v_lshl_add_u32 v10, v10, 4, v25
    v_cndmask_b32 v9, v26, v18, vcc
    v_cndmask_b32 v10, v26, v10, vcc
    v_cmp_eq_u32 vcc, 4, v27
    s_mul_i32 s98, s50, 7168
    s_add_u32 s98, s98, 8716288
    v_cndmask_b32 v10, v10, v18, vcc
    s_lshl_b32 s67, s50, 8
    s_add_u32 s67, s67, 8781824
    v_lshrrev_b32 v11, 5, v0
    v_lshlrev_b32 v11, 10, v11
    v_add_u32 v11, s67, v11
    v_mov_b32 v27, v11
    s_lshr_b32 s67, s68, 1
    s_lshl_b32 s67, s67, 3
    s_add_u32 s67, s67, s50
    s_lshl_b32 s67, s67, 8
    s_add_u32 s67, s67, 8798208
    v_writelane_b32 v11, s67, 0
    s_add_u32 s67, s67, 1024
    v_writelane_b32 v11, s67, 1
    s_lshr_b32 s67, s68, 3
    s_add_u32 s67, s67, 2
    s_bfe_u32 s67, s67, 0x10002
    s_mul_i32 s67, s67, 20
    s_mul_i32 s70, s69, 5
    s_add_u32 s67, s67, s70
    s_lshl_b32 s67, s67, 8
    s_add_u32 s67, s67, 8784896
    v_mov_b32 v12, s67
    s_lshl_b32 s71, s66, 8
    s_add_u32 s67, s67, s71
    s_sub_u32 s67, s67, 1024
    v_writelane_b32 v12, s67, 0
    s_lshl_b32 s70, s70, 11
    s_add_u32 s100, s100, s70
    s_lshl_b32 s101, s66, 11
    s_setprio 0
    s_branch Ls3
Lctype:
    s_mov_b32 s74, 0x3fb8aa3b
    s_mov_b32 s75, 0x3fb8aa3b
    s_mov_b32 s79, 0x358637bd
    s_mul_i32 s66, s54, 8
    s_lshl_b32 s76, s53, 4
    s_add_u32 s76, s76, s66
    s_add_u32 s76, s76, s52
    s_sub_u32 s76, s76, s51
    s_mov_b32 s59, s76
    s_cmp_ge_u32 s50, 6
    s_cbranch_scc1 Lcaux
    s_mov_b32 s99, s76
    s_mov_b32 s65, s50
    v_lshrrev_b32 v157, 3, v0
    v_and_b32 v158, 7, v0
    v_mul_u32_u24 v159, 5120, v157
    v_lshl_add_u32 v159, v158, 4, v159
    s_mul_i32 s66, s99, 40960
    s_lshl_b32 s67, s65, 7
    s_add_u32 s66, s66, s67
    v_add_u32 v220, s66, v159
    v_subrev_u32 v221, 3840, v220
    v_lshlrev_b32 v222, 6, v158
    s_lshl_b32 s67, s65, 9
    s_mov_b32 s18, 2621440
    s_mov_b32 s19, 0x20000
    s_mov_b32 s22, 2621440
    s_mov_b32 s23, 0x20000
    s_mov_b32 s26, 5120
    s_mov_b32 s27, 0x20000
    s_waitcnt lgkmcnt(0)
    buffer_load_dwordx4 v[172:175], v220, s[16:19], 0 offen offset:0
    buffer_load_dwordx4 v[176:179], v220, s[16:19], 0 offen offset:1280
    buffer_load_dwordx4 v[180:183], v220, s[16:19], 0 offen offset:2560
    buffer_load_dwordx4 v[184:187], v220, s[16:19], 0 offen offset:3840
    buffer_load_dwordx4 v[160:163], v221, s[16:19], 0 offen offset:0
    buffer_load_dwordx4 v[164:167], v221, s[16:19], 0 offen offset:1280
    buffer_load_dwordx4 v[168:171], v221, s[16:19], 0 offen offset:2560
    buffer_load_dwordx4 v[188:191], v220, s[20:23], 0 offen offset:0
    buffer_load_dwordx4 v[192:195], v220, s[20:23], 0 offen offset:1280
    buffer_load_dwordx4 v[196:199], v220, s[20:23], 0 offen offset:2560
    buffer_load_dwordx4 v[200:203], v220, s[20:23], 0 offen offset:3840
    buffer_load_dwordx4 v[204:207], v222, s[24:27], s67 offen offset:0
    buffer_load_dwordx4 v[208:211], v222, s[24:27], s67 offen offset:16
    buffer_load_dwordx4 v[212:215], v222, s[24:27], s67 offen offset:32
    buffer_load_dwordx4 v[216:219], v222, s[24:27], s67 offen offset:48
    s_mov_b32 s46, 9437184
    s_mov_b32 s47, 0x20000
    s_cmp_ge_u32 s50, 4
    s_cbranch_scc1 Lc1
    s_add_u32 s65, s50, 6
    v_lshrrev_b32 v157, 3, v0
    v_and_b32 v158, 7, v0
    v_mul_u32_u24 v159, 5120, v157
    v_lshl_add_u32 v159, v158, 4, v159
    s_mul_i32 s66, s99, 40960
    s_lshl_b32 s67, s65, 7
    s_add_u32 s66, s66, s67
    v_add_u32 v220, s66, v159
    v_subrev_u32 v221, 3840, v220
    v_lshlrev_b32 v222, 6, v158
    s_lshl_b32 s67, s65, 9
    buffer_load_dwordx4 v[44:47], v220, s[16:19], 0 offen offset:0
    buffer_load_dwordx4 v[48:51], v220, s[16:19], 0 offen offset:1280
    buffer_load_dwordx4 v[52:55], v220, s[16:19], 0 offen offset:2560
    buffer_load_dwordx4 v[56:59], v220, s[16:19], 0 offen offset:3840
    buffer_load_dwordx4 v[32:35], v221, s[16:19], 0 offen offset:0
    buffer_load_dwordx4 v[36:39], v221, s[16:19], 0 offen offset:1280
    buffer_load_dwordx4 v[40:43], v221, s[16:19], 0 offen offset:2560
    buffer_load_dwordx4 v[60:63], v220, s[20:23], 0 offen offset:0
    buffer_load_dwordx4 v[64:67], v220, s[20:23], 0 offen offset:1280
    buffer_load_dwordx4 v[68:71], v220, s[20:23], 0 offen offset:2560
    buffer_load_dwordx4 v[72:75], v220, s[20:23], 0 offen offset:3840
    buffer_load_dwordx4 v[76:79], v222, s[24:27], s67 offen offset:0
    buffer_load_dwordx4 v[80:83], v222, s[24:27], s67 offen offset:16
    buffer_load_dwordx4 v[84:87], v222, s[24:27], s67 offen offset:32
    buffer_load_dwordx4 v[88:91], v222, s[24:27], s67 offen offset:48
    s_mov_b32 s65, s50
Lc1:
Lcs0:
    s_mul_i32 s68, s50, 4608
    s_add_u32 s68, s68, 0
    v_mul_u32_u24 v223, 576, v157
    v_lshl_add_u32 v223, v158, 4, v223
    v_add_u32 v223, s68, v223
    v_and_b32 v224, 15, v0
    v_mul_u32_u24 v225, 144, v224
    v_lshrrev_b32 v226, 4, v0
    v_lshl_add_u32 v225, v226, 3, v225
    v_add_u32 v225, s68, v225
    s_and_b32 s66, s99, 3
    v_xor_b32 v224, s66, v224
    v_lshlrev_b32 v224, 4, v224
    v_lshl_add_u32 v224, v226, 14, v224
    s_lshl_b32 s66, s65, 18
    s_lshl_b32 s67, s99, 8
    s_add_u32 s66, s66, s67
    s_mov_b32 s67, 0xffff0000
    s_cmp_lt_u32 s50, 4
    s_cbranch_scc1 Lc2
    s_waitcnt vmcnt(0)
Lc2:
    s_waitcnt vmcnt(15)
    v_lshlrev_b32 v134, 16, v204
    v_and_b32 v136, s67, v204
    v_lshlrev_b32 v138, 16, v205
    v_and_b32 v140, s67, v205
    v_lshlrev_b32 v135, 16, v206
    v_and_b32 v137, s67, v206
    v_lshlrev_b32 v139, 16, v207
    v_and_b32 v141, s67, v207
    v_lshlrev_b32 v112, 16, v160
    v_and_b32 v113, s67, v160
    v_lshlrev_b32 v114, 16, v164
    v_and_b32 v115, s67, v164
    v_lshlrev_b32 v116, 16, v168
    v_and_b32 v117, s67, v168
    v_lshlrev_b32 v118, 16, v172
    v_and_b32 v119, s67, v172
    v_lshlrev_b32 v120, 16, v176
    v_and_b32 v121, s67, v176
    v_lshlrev_b32 v122, 16, v180
    v_and_b32 v123, s67, v180
    v_lshlrev_b32 v124, 16, v184
    v_and_b32 v125, s67, v184
    v_lshlrev_b32 v126, 16, v188
    v_and_b32 v127, s67, v188
    v_lshlrev_b32 v128, 16, v192
    v_and_b32 v129, s67, v192
    v_lshlrev_b32 v130, 16, v196
    v_and_b32 v131, s67, v196
    v_lshlrev_b32 v132, 16, v200
    v_and_b32 v133, s67, v200
    v_pk_mul_f32 v[244:245], v[118:119], v[134:135]
    v_pk_mul_f32 v[246:247], v[120:121], v[134:135]
    v_pk_mul_f32 v[248:249], v[122:123], v[134:135]
    v_pk_mul_f32 v[250:251], v[124:125], v[134:135]
    v_pk_fma_f32 v[244:245], v[116:117], v[136:137], v[244:245]
    v_pk_fma_f32 v[246:247], v[118:119], v[136:137], v[246:247]
    v_pk_fma_f32 v[248:249], v[120:121], v[136:137], v[248:249]
    v_pk_fma_f32 v[250:251], v[122:123], v[136:137], v[250:251]
    v_pk_fma_f32 v[244:245], v[114:115], v[138:139], v[244:245]
    v_pk_fma_f32 v[246:247], v[116:117], v[138:139], v[246:247]
    v_pk_fma_f32 v[248:249], v[118:119], v[138:139], v[248:249]
    v_pk_fma_f32 v[250:251], v[120:121], v[138:139], v[250:251]
    v_pk_fma_f32 v[244:245], v[112:113], v[140:141], v[244:245]
    v_pk_fma_f32 v[246:247], v[114:115], v[140:141], v[246:247]
    v_pk_fma_f32 v[248:249], v[116:117], v[140:141], v[248:249]
    v_pk_fma_f32 v[250:251], v[118:119], v[140:141], v[250:251]
    v_pk_mul_f32 v[244:245], v[244:245], v[126:127]
    v_pk_mul_f32 v[246:247], v[246:247], v[128:129]
    v_pk_mul_f32 v[248:249], v[248:249], v[130:131]
    v_pk_mul_f32 v[250:251], v[250:251], v[132:133]
    v_cvt_pk_bf16_f32 v228, v244, v245
    v_cvt_pk_bf16_f32 v232, v246, v247
    v_cvt_pk_bf16_f32 v236, v248, v249
    v_cvt_pk_bf16_f32 v240, v250, v251
    v_lshlrev_b32 v134, 16, v208
    v_and_b32 v136, s67, v208
    v_lshlrev_b32 v138, 16, v209
    v_and_b32 v140, s67, v209
    v_lshlrev_b32 v135, 16, v210
    v_and_b32 v137, s67, v210
    v_lshlrev_b32 v139, 16, v211
    v_and_b32 v141, s67, v211
    v_lshlrev_b32 v112, 16, v161
    v_and_b32 v113, s67, v161
    v_lshlrev_b32 v114, 16, v165
    v_and_b32 v115, s67, v165
    v_lshlrev_b32 v116, 16, v169
    v_and_b32 v117, s67, v169
    v_lshlrev_b32 v118, 16, v173
    v_and_b32 v119, s67, v173
    v_lshlrev_b32 v120, 16, v177
    v_and_b32 v121, s67, v177
    v_lshlrev_b32 v122, 16, v181
    v_and_b32 v123, s67, v181
    v_lshlrev_b32 v124, 16, v185
    v_and_b32 v125, s67, v185
    v_lshlrev_b32 v126, 16, v189
    v_and_b32 v127, s67, v189
    v_lshlrev_b32 v128, 16, v193
    v_and_b32 v129, s67, v193
    v_lshlrev_b32 v130, 16, v197
    v_and_b32 v131, s67, v197
    v_lshlrev_b32 v132, 16, v201
    v_and_b32 v133, s67, v201
    v_pk_mul_f32 v[244:245], v[118:119], v[134:135]
    v_pk_mul_f32 v[246:247], v[120:121], v[134:135]
    v_pk_mul_f32 v[248:249], v[122:123], v[134:135]
    v_pk_mul_f32 v[250:251], v[124:125], v[134:135]
    v_pk_fma_f32 v[244:245], v[116:117], v[136:137], v[244:245]
    v_pk_fma_f32 v[246:247], v[118:119], v[136:137], v[246:247]
    v_pk_fma_f32 v[248:249], v[120:121], v[136:137], v[248:249]
    v_pk_fma_f32 v[250:251], v[122:123], v[136:137], v[250:251]
    v_pk_fma_f32 v[244:245], v[114:115], v[138:139], v[244:245]
    v_pk_fma_f32 v[246:247], v[116:117], v[138:139], v[246:247]
    v_pk_fma_f32 v[248:249], v[118:119], v[138:139], v[248:249]
    v_pk_fma_f32 v[250:251], v[120:121], v[138:139], v[250:251]
    v_pk_fma_f32 v[244:245], v[112:113], v[140:141], v[244:245]
    v_pk_fma_f32 v[246:247], v[114:115], v[140:141], v[246:247]
    v_pk_fma_f32 v[248:249], v[116:117], v[140:141], v[248:249]
    v_pk_fma_f32 v[250:251], v[118:119], v[140:141], v[250:251]
    v_pk_mul_f32 v[244:245], v[244:245], v[126:127]
    v_pk_mul_f32 v[246:247], v[246:247], v[128:129]
    v_pk_mul_f32 v[248:249], v[248:249], v[130:131]
    v_pk_mul_f32 v[250:251], v[250:251], v[132:133]
    v_cvt_pk_bf16_f32 v229, v244, v245
    v_cvt_pk_bf16_f32 v233, v246, v247
    v_cvt_pk_bf16_f32 v237, v248, v249
    v_cvt_pk_bf16_f32 v241, v250, v251
    v_lshlrev_b32 v134, 16, v212
    v_and_b32 v136, s67, v212
    v_lshlrev_b32 v138, 16, v213
    v_and_b32 v140, s67, v213
    v_lshlrev_b32 v135, 16, v214
    v_and_b32 v137, s67, v214
    v_lshlrev_b32 v139, 16, v215
    v_and_b32 v141, s67, v215
    v_lshlrev_b32 v112, 16, v162
    v_and_b32 v113, s67, v162
    v_lshlrev_b32 v114, 16, v166
    v_and_b32 v115, s67, v166
    v_lshlrev_b32 v116, 16, v170
    v_and_b32 v117, s67, v170
    v_lshlrev_b32 v118, 16, v174
    v_and_b32 v119, s67, v174
    v_lshlrev_b32 v120, 16, v178
    v_and_b32 v121, s67, v178
    v_lshlrev_b32 v122, 16, v182
    v_and_b32 v123, s67, v182
    v_lshlrev_b32 v124, 16, v186
    v_and_b32 v125, s67, v186
    v_lshlrev_b32 v126, 16, v190
    v_and_b32 v127, s67, v190
    v_lshlrev_b32 v128, 16, v194
    v_and_b32 v129, s67, v194
    v_lshlrev_b32 v130, 16, v198
    v_and_b32 v131, s67, v198
    v_lshlrev_b32 v132, 16, v202
    v_and_b32 v133, s67, v202
    v_pk_mul_f32 v[244:245], v[118:119], v[134:135]
    v_pk_mul_f32 v[246:247], v[120:121], v[134:135]
    v_pk_mul_f32 v[248:249], v[122:123], v[134:135]
    v_pk_mul_f32 v[250:251], v[124:125], v[134:135]
    v_pk_fma_f32 v[244:245], v[116:117], v[136:137], v[244:245]
    v_pk_fma_f32 v[246:247], v[118:119], v[136:137], v[246:247]
    v_pk_fma_f32 v[248:249], v[120:121], v[136:137], v[248:249]
    v_pk_fma_f32 v[250:251], v[122:123], v[136:137], v[250:251]
    v_pk_fma_f32 v[244:245], v[114:115], v[138:139], v[244:245]
    v_pk_fma_f32 v[246:247], v[116:117], v[138:139], v[246:247]
    v_pk_fma_f32 v[248:249], v[118:119], v[138:139], v[248:249]
    v_pk_fma_f32 v[250:251], v[120:121], v[138:139], v[250:251]
    v_pk_fma_f32 v[244:245], v[112:113], v[140:141], v[244:245]
    v_pk_fma_f32 v[246:247], v[114:115], v[140:141], v[246:247]
    v_pk_fma_f32 v[248:249], v[116:117], v[140:141], v[248:249]
    v_pk_fma_f32 v[250:251], v[118:119], v[140:141], v[250:251]
    v_pk_mul_f32 v[244:245], v[244:245], v[126:127]
    v_pk_mul_f32 v[246:247], v[246:247], v[128:129]
    v_pk_mul_f32 v[248:249], v[248:249], v[130:131]
    v_pk_mul_f32 v[250:251], v[250:251], v[132:133]
    v_cvt_pk_bf16_f32 v230, v244, v245
    v_cvt_pk_bf16_f32 v234, v246, v247
    v_cvt_pk_bf16_f32 v238, v248, v249
    v_cvt_pk_bf16_f32 v242, v250, v251
    v_lshlrev_b32 v134, 16, v216
    v_and_b32 v136, s67, v216
    v_lshlrev_b32 v138, 16, v217
    v_and_b32 v140, s67, v217
    v_lshlrev_b32 v135, 16, v218
    v_and_b32 v137, s67, v218
    v_lshlrev_b32 v139, 16, v219
    v_and_b32 v141, s67, v219
    v_lshlrev_b32 v112, 16, v163
    v_and_b32 v113, s67, v163
    v_lshlrev_b32 v114, 16, v167
    v_and_b32 v115, s67, v167
    v_lshlrev_b32 v116, 16, v171
    v_and_b32 v117, s67, v171
    v_lshlrev_b32 v118, 16, v175
    v_and_b32 v119, s67, v175
    v_lshlrev_b32 v120, 16, v179
    v_and_b32 v121, s67, v179
    v_lshlrev_b32 v122, 16, v183
    v_and_b32 v123, s67, v183
    v_lshlrev_b32 v124, 16, v187
    v_and_b32 v125, s67, v187
    v_lshlrev_b32 v126, 16, v191
    v_and_b32 v127, s67, v191
    v_lshlrev_b32 v128, 16, v195
    v_and_b32 v129, s67, v195
    v_lshlrev_b32 v130, 16, v199
    v_and_b32 v131, s67, v199
    v_lshlrev_b32 v132, 16, v203
    v_and_b32 v133, s67, v203
    v_pk_mul_f32 v[244:245], v[118:119], v[134:135]
    v_pk_mul_f32 v[246:247], v[120:121], v[134:135]
    v_pk_mul_f32 v[248:249], v[122:123], v[134:135]
    v_pk_mul_f32 v[250:251], v[124:125], v[134:135]
    v_pk_fma_f32 v[244:245], v[116:117], v[136:137], v[244:245]
    v_pk_fma_f32 v[246:247], v[118:119], v[136:137], v[246:247]
    v_pk_fma_f32 v[248:249], v[120:121], v[136:137], v[248:249]
    v_pk_fma_f32 v[250:251], v[122:123], v[136:137], v[250:251]
    v_pk_fma_f32 v[244:245], v[114:115], v[138:139], v[244:245]
    v_pk_fma_f32 v[246:247], v[116:117], v[138:139], v[246:247]
    v_pk_fma_f32 v[248:249], v[118:119], v[138:139], v[248:249]
    v_pk_fma_f32 v[250:251], v[120:121], v[138:139], v[250:251]
    v_pk_fma_f32 v[244:245], v[112:113], v[140:141], v[244:245]
    v_pk_fma_f32 v[246:247], v[114:115], v[140:141], v[246:247]
    v_pk_fma_f32 v[248:249], v[116:117], v[140:141], v[248:249]
    v_pk_fma_f32 v[250:251], v[118:119], v[140:141], v[250:251]
    v_pk_mul_f32 v[244:245], v[244:245], v[126:127]
    v_pk_mul_f32 v[246:247], v[246:247], v[128:129]
    v_pk_mul_f32 v[248:249], v[248:249], v[130:131]
    v_pk_mul_f32 v[250:251], v[250:251], v[132:133]
    v_cvt_pk_bf16_f32 v231, v244, v245
    v_cvt_pk_bf16_f32 v235, v246, v247
    v_cvt_pk_bf16_f32 v239, v248, v249
    v_cvt_pk_bf16_f32 v243, v250, v251
    ds_write_b128 v223, v[228:231] offset:0
    ds_write_b128 v223, v[232:235] offset:144
    ds_write_b128 v223, v[236:239] offset:288
    ds_write_b128 v223, v[240:243] offset:432
    ds_read_b64_tr_b16 v[160:161], v225 offset:0
    ds_read_b64_tr_b16 v[162:163], v225 offset:2304
    ds_read_b64_tr_b16 v[164:165], v225 offset:32
    ds_read_b64_tr_b16 v[166:167], v225 offset:2336
    ds_read_b64_tr_b16 v[168:169], v225 offset:64
    ds_read_b64_tr_b16 v[170:171], v225 offset:2368
    ds_read_b64_tr_b16 v[172:173], v225 offset:96
    ds_read_b64_tr_b16 v[174:175], v225 offset:2400
    s_waitcnt lgkmcnt(6)
    buffer_store_dwordx4 v[160:163], v224, s[44:47], s66 offen sc1
    s_add_u32 s66, s66, 65536
    s_waitcnt lgkmcnt(4)
    buffer_store_dwordx4 v[164:167], v224, s[44:47], s66 offen sc1
    s_add_u32 s66, s66, 65536
    s_waitcnt lgkmcnt(2)
    buffer_store_dwordx4 v[168:171], v224, s[44:47], s66 offen sc1
    s_add_u32 s66, s66, 65536
    s_waitcnt lgkmcnt(0)
    buffer_store_dwordx4 v[172:175], v224, s[44:47], s66 offen sc1
    s_cmp_ge_u32 s50, 4
    s_cbranch_scc1 Lcjoin
    s_add_u32 s65, s50, 6
    v_mul_u32_u24 v223, 576, v157
    v_lshl_add_u32 v223, v158, 4, v223
    v_add_u32 v223, s68, v223
    v_and_b32 v224, 15, v0
    v_mul_u32_u24 v225, 144, v224
    v_lshrrev_b32 v226, 4, v0
    v_lshl_add_u32 v225, v226, 3, v225
    v_add_u32 v225, s68, v225
    s_and_b32 s66, s99, 3
    v_xor_b32 v224, s66, v224
    v_lshlrev_b32 v224, 4, v224
    v_lshl_add_u32 v224, v226, 14, v224
    s_lshl_b32 s66, s65, 18
    s_lshl_b32 s67, s99, 8
    s_add_u32 s66, s66, s67
    s_mov_b32 s67, 0xffff0000
    s_waitcnt vmcnt(4)
    v_lshlrev_b32 v134, 16, v76
    v_and_b32 v136, s67, v76
    v_lshlrev_b32 v138, 16, v77
    v_and_b32 v140, s67, v77
    v_lshlrev_b32 v135, 16, v78
    v_and_b32 v137, s67, v78
    v_lshlrev_b32 v139, 16, v79
    v_and_b32 v141, s67, v79
    v_lshlrev_b32 v112, 16, v32
    v_and_b32 v113, s67, v32
    v_lshlrev_b32 v114, 16, v36
    v_and_b32 v115, s67, v36
    v_lshlrev_b32 v116, 16, v40
    v_and_b32 v117, s67, v40
    v_lshlrev_b32 v118, 16, v44
    v_and_b32 v119, s67, v44
    v_lshlrev_b32 v120, 16, v48
    v_and_b32 v121, s67, v48
    v_lshlrev_b32 v122, 16, v52
    v_and_b32 v123, s67, v52
    v_lshlrev_b32 v124, 16, v56
    v_and_b32 v125, s67, v56
    v_lshlrev_b32 v126, 16, v60
    v_and_b32 v127, s67, v60
    v_lshlrev_b32 v128, 16, v64
    v_and_b32 v129, s67, v64
    v_lshlrev_b32 v130, 16, v68
    v_and_b32 v131, s67, v68
    v_lshlrev_b32 v132, 16, v72
    v_and_b32 v133, s67, v72
    v_pk_mul_f32 v[244:245], v[118:119], v[134:135]
    v_pk_mul_f32 v[246:247], v[120:121], v[134:135]
    v_pk_mul_f32 v[248:249], v[122:123], v[134:135]
    v_pk_mul_f32 v[250:251], v[124:125], v[134:135]
    v_pk_fma_f32 v[244:245], v[116:117], v[136:137], v[244:245]
    v_pk_fma_f32 v[246:247], v[118:119], v[136:137], v[246:247]
    v_pk_fma_f32 v[248:249], v[120:121], v[136:137], v[248:249]
    v_pk_fma_f32 v[250:251], v[122:123], v[136:137], v[250:251]
    v_pk_fma_f32 v[244:245], v[114:115], v[138:139], v[244:245]
    v_pk_fma_f32 v[246:247], v[116:117], v[138:139], v[246:247]
    v_pk_fma_f32 v[248:249], v[118:119], v[138:139], v[248:249]
    v_pk_fma_f32 v[250:251], v[120:121], v[138:139], v[250:251]
    v_pk_fma_f32 v[244:245], v[112:113], v[140:141], v[244:245]
    v_pk_fma_f32 v[246:247], v[114:115], v[140:141], v[246:247]
    v_pk_fma_f32 v[248:249], v[116:117], v[140:141], v[248:249]
    v_pk_fma_f32 v[250:251], v[118:119], v[140:141], v[250:251]
    v_pk_mul_f32 v[244:245], v[244:245], v[126:127]
    v_pk_mul_f32 v[246:247], v[246:247], v[128:129]
    v_pk_mul_f32 v[248:249], v[248:249], v[130:131]
    v_pk_mul_f32 v[250:251], v[250:251], v[132:133]
    v_cvt_pk_bf16_f32 v228, v244, v245
    v_cvt_pk_bf16_f32 v232, v246, v247
    v_cvt_pk_bf16_f32 v236, v248, v249
    v_cvt_pk_bf16_f32 v240, v250, v251
    v_lshlrev_b32 v134, 16, v80
    v_and_b32 v136, s67, v80
    v_lshlrev_b32 v138, 16, v81
    v_and_b32 v140, s67, v81
    v_lshlrev_b32 v135, 16, v82
    v_and_b32 v137, s67, v82
    v_lshlrev_b32 v139, 16, v83
    v_and_b32 v141, s67, v83
    v_lshlrev_b32 v112, 16, v33
    v_and_b32 v113, s67, v33
    v_lshlrev_b32 v114, 16, v37
    v_and_b32 v115, s67, v37
    v_lshlrev_b32 v116, 16, v41
    v_and_b32 v117, s67, v41
    v_lshlrev_b32 v118, 16, v45
    v_and_b32 v119, s67, v45
    v_lshlrev_b32 v120, 16, v49
    v_and_b32 v121, s67, v49
    v_lshlrev_b32 v122, 16, v53
    v_and_b32 v123, s67, v53
    v_lshlrev_b32 v124, 16, v57
    v_and_b32 v125, s67, v57
    v_lshlrev_b32 v126, 16, v61
    v_and_b32 v127, s67, v61
    v_lshlrev_b32 v128, 16, v65
    v_and_b32 v129, s67, v65
    v_lshlrev_b32 v130, 16, v69
    v_and_b32 v131, s67, v69
    v_lshlrev_b32 v132, 16, v73
    v_and_b32 v133, s67, v73
    v_pk_mul_f32 v[244:245], v[118:119], v[134:135]
    v_pk_mul_f32 v[246:247], v[120:121], v[134:135]
    v_pk_mul_f32 v[248:249], v[122:123], v[134:135]
    v_pk_mul_f32 v[250:251], v[124:125], v[134:135]
    v_pk_fma_f32 v[244:245], v[116:117], v[136:137], v[244:245]
    v_pk_fma_f32 v[246:247], v[118:119], v[136:137], v[246:247]
    v_pk_fma_f32 v[248:249], v[120:121], v[136:137], v[248:249]
    v_pk_fma_f32 v[250:251], v[122:123], v[136:137], v[250:251]
    v_pk_fma_f32 v[244:245], v[114:115], v[138:139], v[244:245]
    v_pk_fma_f32 v[246:247], v[116:117], v[138:139], v[246:247]
    v_pk_fma_f32 v[248:249], v[118:119], v[138:139], v[248:249]
    v_pk_fma_f32 v[250:251], v[120:121], v[138:139], v[250:251]
    v_pk_fma_f32 v[244:245], v[112:113], v[140:141], v[244:245]
    v_pk_fma_f32 v[246:247], v[114:115], v[140:141], v[246:247]
    v_pk_fma_f32 v[248:249], v[116:117], v[140:141], v[248:249]
    v_pk_fma_f32 v[250:251], v[118:119], v[140:141], v[250:251]
    v_pk_mul_f32 v[244:245], v[244:245], v[126:127]
    v_pk_mul_f32 v[246:247], v[246:247], v[128:129]
    v_pk_mul_f32 v[248:249], v[248:249], v[130:131]
    v_pk_mul_f32 v[250:251], v[250:251], v[132:133]
    v_cvt_pk_bf16_f32 v229, v244, v245
    v_cvt_pk_bf16_f32 v233, v246, v247
    v_cvt_pk_bf16_f32 v237, v248, v249
    v_cvt_pk_bf16_f32 v241, v250, v251
    v_lshlrev_b32 v134, 16, v84
    v_and_b32 v136, s67, v84
    v_lshlrev_b32 v138, 16, v85
    v_and_b32 v140, s67, v85
    v_lshlrev_b32 v135, 16, v86
    v_and_b32 v137, s67, v86
    v_lshlrev_b32 v139, 16, v87
    v_and_b32 v141, s67, v87
    v_lshlrev_b32 v112, 16, v34
    v_and_b32 v113, s67, v34
    v_lshlrev_b32 v114, 16, v38
    v_and_b32 v115, s67, v38
    v_lshlrev_b32 v116, 16, v42
    v_and_b32 v117, s67, v42
    v_lshlrev_b32 v118, 16, v46
    v_and_b32 v119, s67, v46
    v_lshlrev_b32 v120, 16, v50
    v_and_b32 v121, s67, v50
    v_lshlrev_b32 v122, 16, v54
    v_and_b32 v123, s67, v54
    v_lshlrev_b32 v124, 16, v58
    v_and_b32 v125, s67, v58
    v_lshlrev_b32 v126, 16, v62
    v_and_b32 v127, s67, v62
    v_lshlrev_b32 v128, 16, v66
    v_and_b32 v129, s67, v66
    v_lshlrev_b32 v130, 16, v70
    v_and_b32 v131, s67, v70
    v_lshlrev_b32 v132, 16, v74
    v_and_b32 v133, s67, v74
    v_pk_mul_f32 v[244:245], v[118:119], v[134:135]
    v_pk_mul_f32 v[246:247], v[120:121], v[134:135]
    v_pk_mul_f32 v[248:249], v[122:123], v[134:135]
    v_pk_mul_f32 v[250:251], v[124:125], v[134:135]
    v_pk_fma_f32 v[244:245], v[116:117], v[136:137], v[244:245]
    v_pk_fma_f32 v[246:247], v[118:119], v[136:137], v[246:247]
    v_pk_fma_f32 v[248:249], v[120:121], v[136:137], v[248:249]
    v_pk_fma_f32 v[250:251], v[122:123], v[136:137], v[250:251]
    v_pk_fma_f32 v[244:245], v[114:115], v[138:139], v[244:245]
    v_pk_fma_f32 v[246:247], v[116:117], v[138:139], v[246:247]
    v_pk_fma_f32 v[248:249], v[118:119], v[138:139], v[248:249]
    v_pk_fma_f32 v[250:251], v[120:121], v[138:139], v[250:251]
    v_pk_fma_f32 v[244:245], v[112:113], v[140:141], v[244:245]
    v_pk_fma_f32 v[246:247], v[114:115], v[140:141], v[246:247]
    v_pk_fma_f32 v[248:249], v[116:117], v[140:141], v[248:249]
    v_pk_fma_f32 v[250:251], v[118:119], v[140:141], v[250:251]
    v_pk_mul_f32 v[244:245], v[244:245], v[126:127]
    v_pk_mul_f32 v[246:247], v[246:247], v[128:129]
    v_pk_mul_f32 v[248:249], v[248:249], v[130:131]
    v_pk_mul_f32 v[250:251], v[250:251], v[132:133]
    v_cvt_pk_bf16_f32 v230, v244, v245
    v_cvt_pk_bf16_f32 v234, v246, v247
    v_cvt_pk_bf16_f32 v238, v248, v249
    v_cvt_pk_bf16_f32 v242, v250, v251
    v_lshlrev_b32 v134, 16, v88
    v_and_b32 v136, s67, v88
    v_lshlrev_b32 v138, 16, v89
    v_and_b32 v140, s67, v89
    v_lshlrev_b32 v135, 16, v90
    v_and_b32 v137, s67, v90
    v_lshlrev_b32 v139, 16, v91
    v_and_b32 v141, s67, v91
    v_lshlrev_b32 v112, 16, v35
    v_and_b32 v113, s67, v35
    v_lshlrev_b32 v114, 16, v39
    v_and_b32 v115, s67, v39
    v_lshlrev_b32 v116, 16, v43
    v_and_b32 v117, s67, v43
    v_lshlrev_b32 v118, 16, v47
    v_and_b32 v119, s67, v47
    v_lshlrev_b32 v120, 16, v51
    v_and_b32 v121, s67, v51
    v_lshlrev_b32 v122, 16, v55
    v_and_b32 v123, s67, v55
    v_lshlrev_b32 v124, 16, v59
    v_and_b32 v125, s67, v59
    v_lshlrev_b32 v126, 16, v63
    v_and_b32 v127, s67, v63
    v_lshlrev_b32 v128, 16, v67
    v_and_b32 v129, s67, v67
    v_lshlrev_b32 v130, 16, v71
    v_and_b32 v131, s67, v71
    v_lshlrev_b32 v132, 16, v75
    v_and_b32 v133, s67, v75
    v_pk_mul_f32 v[244:245], v[118:119], v[134:135]
    v_pk_mul_f32 v[246:247], v[120:121], v[134:135]
    v_pk_mul_f32 v[248:249], v[122:123], v[134:135]
    v_pk_mul_f32 v[250:251], v[124:125], v[134:135]
    v_pk_fma_f32 v[244:245], v[116:117], v[136:137], v[244:245]
    v_pk_fma_f32 v[246:247], v[118:119], v[136:137], v[246:247]
    v_pk_fma_f32 v[248:249], v[120:121], v[136:137], v[248:249]
    v_pk_fma_f32 v[250:251], v[122:123], v[136:137], v[250:251]
    v_pk_fma_f32 v[244:245], v[114:115], v[138:139], v[244:245]
    v_pk_fma_f32 v[246:247], v[116:117], v[138:139], v[246:247]
    v_pk_fma_f32 v[248:249], v[118:119], v[138:139], v[248:249]
    v_pk_fma_f32 v[250:251], v[120:121], v[138:139], v[250:251]
    v_pk_fma_f32 v[244:245], v[112:113], v[140:141], v[244:245]
    v_pk_fma_f32 v[246:247], v[114:115], v[140:141], v[246:247]
    v_pk_fma_f32 v[248:249], v[116:117], v[140:141], v[248:249]
    v_pk_fma_f32 v[250:251], v[118:119], v[140:141], v[250:251]
    v_pk_mul_f32 v[244:245], v[244:245], v[126:127]
    v_pk_mul_f32 v[246:247], v[246:247], v[128:129]
    v_pk_mul_f32 v[248:249], v[248:249], v[130:131]
    v_pk_mul_f32 v[250:251], v[250:251], v[132:133]
    v_cvt_pk_bf16_f32 v231, v244, v245
    v_cvt_pk_bf16_f32 v235, v246, v247
    v_cvt_pk_bf16_f32 v239, v248, v249
    v_cvt_pk_bf16_f32 v243, v250, v251
    ds_write_b128 v223, v[228:231] offset:0
    ds_write_b128 v223, v[232:235] offset:144
    ds_write_b128 v223, v[236:239] offset:288
    ds_write_b128 v223, v[240:243] offset:432
    ds_read_b64_tr_b16 v[32:33], v225 offset:0
    ds_read_b64_tr_b16 v[34:35], v225 offset:2304
    ds_read_b64_tr_b16 v[36:37], v225 offset:32
    ds_read_b64_tr_b16 v[38:39], v225 offset:2336
    ds_read_b64_tr_b16 v[40:41], v225 offset:64
    ds_read_b64_tr_b16 v[42:43], v225 offset:2368
    ds_read_b64_tr_b16 v[44:45], v225 offset:96
    ds_read_b64_tr_b16 v[46:47], v225 offset:2400
    s_waitcnt lgkmcnt(6)
    buffer_store_dwordx4 v[32:35], v224, s[44:47], s66 offen sc1
    s_add_u32 s66, s66, 65536
    s_waitcnt lgkmcnt(4)
    buffer_store_dwordx4 v[36:39], v224, s[44:47], s66 offen sc1
    s_add_u32 s66, s66, 65536
    s_waitcnt lgkmcnt(2)
    buffer_store_dwordx4 v[40:43], v224, s[44:47], s66 offen sc1
    s_add_u32 s66, s66, 65536
    s_waitcnt lgkmcnt(0)
    buffer_store_dwordx4 v[44:47], v224, s[44:47], s66 offen sc1
    s_branch Lcjoin
Lcaux:
    s_setprio 3
    s_mov_b32 s14, 819200
    s_mov_b32 s15, 0x20000
    s_mov_b32 s46, 9437184
    s_mov_b32 s47, 0x20000
    s_mov_b32 s42, 256
    s_mov_b32 s43, 0x20000
    s_sub_u32 s65, s50, 6
    s_lshl_b32 s62, s76, 1
    s_add_u32 s62, s62, s65
    v_mov_b32 v52, 0
    v_mov_b32 v53, 0
    v_mov_b32 v54, 0
    v_mov_b32 v55, 0
    v_lshlrev_b32 v15, 3, v0
    s_lshl_b32 s66, s62, 9
    s_add_u32 s66, s66, 8716288
    s_waitcnt lgkmcnt(0)
    buffer_store_dwordx2 v[52:53], v15, s[44:47], s66 offen sc1
    s_mul_i32 s66, s62, 768
    s_add_u32 s66, s66, 8781824
    v_lshlrev_b32 v16, 8, v0
    s_mov_b64 exec, 7
    buffer_store_dword v52, v16, s[44:47], s66 offen sc1
    s_mov_b64 exec, -1
Lcrp:
    s_lshr_b32 s66, s62, 2
    s_and_b32 s64, s62, 3
    s_mul_i32 s60, s66, 52
    s_lshr_b32 s60, s60, 8
    s_mul_i32 s67, s60, 5
    s_sub_u32 s63, s66, s67
    s_mul_i32 s66, s63, 20
    s_cmp_eq_u32 s63, 4
    s_cselect_b32 s66, 16, s66
    s_cselect_b32 s68, 16, 0
    s_mul_i32 s67, s60, 80
    s_add_u32 s66, s66, s67
    s_mul_i32 s66, s66, 1280
    s_mul_i32 s67, s64, 320
    s_add_u32 s66, s66, s67
    s_lshr_b32 s69, s62, 7
    s_lshl_b32 s69, s69, 1
    s_add_u32 s69, s69, s65
    s_mul_i32 s69, s69, 5120
    s_add_u32 s69, s69, 49152
    s_waitcnt lgkmcnt(0)
    v_add_u32 v14, 0, v0
    v_mul_u32_u24 v15, 3277, v14
    v_lshrrev_b32 v15, 16, v15
    v_mul_u32_u24 v16, 20, v15
    v_sub_u32 v16, v14, v16
    v_lshrrev_b32 v17, 2, v15
    v_mad_u32_u24 v15, v17, s68, v15
    v_mul_u32_u24 v15, 1280, v15
    v_lshl_add_u32 v15, v16, 4, v15
    s_add_u32 m0, s69, 0
    s_nop 0
    buffer_load_dwordx4 v15, s[12:15], s66 offen lds
    v_add_u32 v14, 64, v0
    v_mul_u32_u24 v15, 3277, v14
    v_lshrrev_b32 v15, 16, v15
    v_mul_u32_u24 v16, 20, v15
    v_sub_u32 v16, v14, v16
    v_lshrrev_b32 v17, 2, v15
    v_mad_u32_u24 v15, v17, s68, v15
    v_mul_u32_u24 v15, 1280, v15
    v_lshl_add_u32 v15, v16, 4, v15
    s_add_u32 m0, s69, 1024
    s_nop 0
    buffer_load_dwordx4 v15, s[12:15], s66 offen lds
    v_add_u32 v14, 128, v0
    v_mul_u32_u24 v15, 3277, v14
    v_lshrrev_b32 v15, 16, v15
    v_mul_u32_u24 v16, 20, v15
    v_sub_u32 v16, v14, v16
    v_lshrrev_b32 v17, 2, v15
    v_mad_u32_u24 v15, v17, s68, v15
    v_mul_u32_u24 v15, 1280, v15
    v_lshl_add_u32 v15, v16, 4, v15
    s_add_u32 m0, s69, 2048
    s_nop 0
    buffer_load_dwordx4 v15, s[12:15], s66 offen lds
    v_add_u32 v14, 192, v0
    v_mul_u32_u24 v15, 3277, v14
    v_lshrrev_b32 v15, 16, v15
    v_mul_u32_u24 v16, 20, v15
    v_sub_u32 v16, v14, v16
    v_lshrrev_b32 v17, 2, v15
    v_mad_u32_u24 v15, v17, s68, v15
    v_mul_u32_u24 v15, 1280, v15
    v_lshl_add_u32 v15, v16, 4, v15
    s_add_u32 m0, s69, 3072
    s_nop 0
    buffer_load_dwordx4 v15, s[12:15], s66 offen lds
    v_add_u32 v14, 256, v0
    v_mul_u32_u24 v15, 3277, v14
    v_lshrrev_b32 v15, 16, v15
    v_mul_u32_u24 v16, 20, v15
    v_sub_u32 v16, v14, v16
    v_lshrrev_b32 v17, 2, v15
    v_mad_u32_u24 v15, v17, s68, v15
    v_mul_u32_u24 v15, 1280, v15
    v_lshl_add_u32 v15, v16, 4, v15
    s_add_u32 m0, s69, 4096
    s_nop 0
    buffer_load_dwordx4 v15, s[12:15], s66 offen lds
    s_add_u32 s62, s62, 128
    s_cmp_lt_u32 s62, 160
    s_cbranch_scc1 Lcrp
    s_and_b32 s62, s62, 127
    s_waitcnt vmcnt(0)
Lcrp2:
    s_lshr_b32 s66, s62, 2
    s_and_b32 s64, s62, 3
    s_mul_i32 s60, s66, 52
    s_lshr_b32 s60, s60, 8
    s_mul_i32 s67, s60, 5
    s_sub_u32 s63, s66, s67
    s_lshr_b32 s69, s62, 7
    s_lshl_b32 s69, s69, 1
    s_add_u32 s69, s69, s65
    s_mul_i32 s69, s69, 5120
    s_add_u32 s69, s69, 49152
    v_lshrrev_b32 v14, 5, v0
    v_bfe_u32 v15, v0, 2, 2
    v_lshl_add_u32 v14, v14, 2, v15
    v_mul_u32_u24 v14, 320, v14
    v_bfe_u32 v15, v0, 4, 1
    v_lshl_add_u32 v14, v15, 5, v14
    v_and_b32 v15, 3, v0
    v_lshl_add_u32 v14, v15, 3, v14
    v_add_u32 v14, s69, v14
    s_mul_i32 s66, s60, 5
    s_add_u32 s66, s66, s63
    s_cmp_ge_u32 s60, 5
    s_cselect_b32 s67, 0x4b, 0
    s_mov_b32 s68, 25
    s_add_u32 s66, s66, s67
    s_mul_i32 s67, s64, 200
    s_add_u32 s66, s66, s67
    s_lshl_b32 s66, s66, 10
    s_add_u32 s66, s66, 7864320
    s_lshl_b32 s68, s68, 10
    s_lshr_b32 s70, s60, 1
    s_mul_i32 s70, s70, 25
    s_and_b32 s71, s60, 1
    s_mul_i32 s71, s71, 5
    s_add_u32 s70, s70, s71
    s_add_u32 s70, s70, s63
    s_add_u32 s70, s70, s67
    s_add_u32 s70, s70, 115
    s_lshl_b32 s70, s70, 10
    s_add_u32 s70, s70, 7864320
    v_lshlrev_b32 v15, 4, v0
    ds_read_b64_tr_b16 v[32:33], v14 offset:0
    ds_read_b64_tr_b16 v[34:35], v14 offset:2560
    ds_read_b64_tr_b16 v[36:37], v14 offset:64
    ds_read_b64_tr_b16 v[38:39], v14 offset:2624
    ds_read_b64_tr_b16 v[40:41], v14 offset:128
    ds_read_b64_tr_b16 v[42:43], v14 offset:2688
    ds_read_b64_tr_b16 v[44:45], v14 offset:192
    ds_read_b64_tr_b16 v[46:47], v14 offset:2752
    ds_read_b64_tr_b16 v[48:49], v14 offset:256
    ds_read_b64_tr_b16 v[50:51], v14 offset:2816
    s_waitcnt lgkmcnt(0)
    buffer_store_dwordx4 v[32:35], v15, s[44:47], s66 offen sc1
    s_add_u32 s66, s66, s68
    buffer_store_dwordx4 v[36:39], v15, s[44:47], s66 offen sc1
    s_add_u32 s66, s66, s68
    buffer_store_dwordx4 v[40:43], v15, s[44:47], s66 offen sc1
    s_add_u32 s66, s66, s68
    buffer_store_dwordx4 v[44:47], v15, s[44:47], s66 offen sc1
    s_add_u32 s66, s66, s68
    buffer_store_dwordx4 v[48:51], v15, s[44:47], s70 offen sc1
    s_add_u32 s62, s62, 128
    s_cmp_lt_u32 s62, 160
    s_cbranch_scc1 Lcrp2
    v_mov_b32 v60, 0
    s_waitcnt vmcnt(0)
    v_mov_b32 v61, 1
    s_mov_b64 exec, 1
    buffer_atomic_add v61, v60, s[40:43], 0 offen offset:4 sc0 sc1
    s_mov_b64 exec, -1
    s_setprio 0
    s_mov_b32 s6, 2621440
    s_mov_b32 s7, 0x20000
    s_mov_b32 s30, 2621440
    s_mov_b32 s31, 0x20000
    s_mov_b32 s38, 2621440
    s_mov_b32 s39, 0x20000
    v_mov_b32 v100, 0
    v_mov_b32 v101, 0
    v_lshlrev_b32 v102, 3, v0
    s_and_b32 s72, s50, 3
    s_lshl_b32 s70, s72, 9
    s_add_u32 s70, s70, 110592
    v_add_u32 v103, s70, v102
    ds_write_b64 v103, v[100:101]
    s_mul_i32 s70, s72, 4224
    s_add_u32 s70, s70, 129024
    v_add_u32 v103, s70, v102
    s_mov_b64 exec, 0xffff
    ds_write_b64 v103, v[100:101]
    v_add_u32 v103, 146048, v102
    s_mov_b64 exec, 0xff
    ds_write_b64 v103, v[100:101]
    s_mov_b64 exec, -1
    s_mov_b32 s67, 0
    s_lshr_b32 s61, s50, 1
    s_and_b32 s62, s50, 1
    s_add_u32 s60, s67, s61
    s_lshl_b32 s63, s59, 2
    s_add_u32 s63, s63, s60
    s_lshl_b32 s70, s63, 1
    s_and_b32 s70, s70, -4
    s_load_dword s77, s[48:49], s70
    v_and_b32 v96, 31, v0
    v_lshrrev_b32 v97, 5, v0
    v_lshl_add_u32 v98, v97, 2, v96
    v_lshrrev_b32 v99, 2, v98
    v_add_u32 v99, 3, v99
    v_and_b32 v99, 3, v99
    v_xor_b32 v99, s60, v99
    v_lshlrev_b32 v99, 4, v99
    v_lshl_add_u32 v99, v98, 6, v99
    v_add_u32 v148, 110848, v99
    v_xor_b32 v149, 32, v148
    v_bfe_u32 v98, v0, 4, 1
    v_and_b32 v99, 3, v0
    v_lshl_add_u32 v98, v98, 2, v99
    v_bfe_u32 v96, v0, 2, 2
    v_sub_u32 v98, v98, v96
    v_lshlrev_b32 v97, 3, v97
    v_sub_u32 v98, v98, v97
    v_lshlrev_b32 v98, 3, v98
    s_mul_i32 s70, s61, 4224
    s_add_u32 s70, s70, 129184
    v_add_u32 v150, s70, v98
    s_lshl_b32 s70, s50, 11
    s_add_u32 s70, s70, 92160
    v_lshlrev_b32 v151, 4, v0
    v_add_u32 v151, s70, v151
    v_lshrrev_b32 v97, 4, v0
    v_lshrrev_b32 v98, 1, v99
    v_lshl_add_u32 v98, v97, 1, v98
    v_lshl_add_u32 v98, v98, 3, v96
    v_lshlrev_b32 v98, 4, v98
    v_and_b32 v99, 1, v99
    v_lshl_add_u32 v98, v99, 3, v98
    v_add_u32 v152, s70, v98
    v_and_b32 v98, 7, v0
    v_lshrrev_b32 v99, 5, v0
    v_lshl_add_u32 v98, v98, 1, v99
    v_mul_u32_u24 v98, 40960, v98
    v_bfe_u32 v99, v0, 3, 2
    v_lshl_add_u32 v154, v99, 4, v98
    s_lshl_b32 s70, s50, 4
    s_add_u32 s70, s70, 145920
    v_mov_b32 v153, s70
    s_lshl_b32 s70, s61, 2
    s_add_u32 s70, s70, 146064
    v_mov_b32 v155, s70
    s_lshr_b32 s66, s52, 1
    s_lshl_b32 s68, s53, 4
    s_add_u32 s68, s68, s66
    s_and_b32 s66, s52, 1
    s_lshl_b32 s69, s54, 1
    s_add_u32 s69, s69, s66
    v_lshlrev_b32 v1, 4, v0
    v_mov_b32 v13, 0
    v_and_b32 v24, 31, v0
    v_lshrrev_b32 v25, 5, v0
    s_and_b32 s66, s50, 3
    s_lshl_b32 s67, s66, 6
    s_lshl_b32 s70, s66, 4
    s_add_u32 s70, s70, 256
    s_cmp_lt_u32 s50, 4
    s_cselect_b32 s67, s67, s70
    s_cselect_b32 s71, 4, 3
    v_mul_u32_u24 v14, 1280, v24
    v_lshl_add_u32 v14, v25, s71, v14
    s_mul_i32 s96, s68, 40960
    s_mul_i32 s70, s69, 320
    s_add_u32 s100, s96, 5242880
    s_add_u32 s96, s96, s70
    s_add_u32 s96, s96, s67
    s_lshl_b32 s71, s68, 7
    s_add_u32 s71, s71, 8962048
    v_lshlrev_b32 v19, 2, v24
    v_add_u32 v19, s71, v19
    v_bfe_u32 v26, v0, 2, 2
    v_lshl_add_u32 v26, v25, 2, v26
    v_lshlrev_b32 v17, 6, v26
    v_bfe_u32 v26, v0, 4, 1
    v_lshl_add_u32 v17, v26, 5, v17
    v_and_b32 v26, 3, v0
    v_lshl_add_u32 v17, v26, 3, v17
    s_lshl_b32 s67, s67, 5
    s_add_u32 s67, s67, 146176
    v_add_u32 v17, s67, v17
    s_lshl_b32 s67, s66, 12
    s_add_u32 s67, s67, 77824
    v_add_u32 v5, s67, v1
    s_lshl_b32 s67, s66, 10
    s_add_u32 s67, s67, 94208
    v_add_u32 v15, s67, v1
    s_mul_i32 s67, s66, 10240
    s_add_u32 s67, s67, 36864
    v_add_u32 v4, s67, v1
    v_add_u32 v3, 36864, v1
    s_mul_i32 s67, s50, 5120
    s_add_u32 s70, s67, 36864
    v_add_u32 v2, s70, v1
    s_add_u32 s97, s100, s67
    s_add_u32 s97, s97, 4292345856
    v_mul_u32_u24 v25, 336, v25
    v_min_u32 v26, 20, v24
    v_lshl_add_u32 v26, v26, 4, v25
    v_lshrrev_b32 v27, 2, v24
    v_mov_b32 v18, 0x7f000000
    v_cmp_eq_u32 vcc, 5, v27
    v_subrev_u32 v10, 4, v24
    v_lshl_add_u32 v10, v10, 4, v25
    v_cndmask_b32 v9, v26, v18, vcc
    v_cndmask_b32 v10, v26, v10, vcc
    v_cmp_eq_u32 vcc, 4, v27
    s_mul_i32 s98, s50, 7168
    s_add_u32 s98, s98, 8716288
    v_cndmask_b32 v10, v10, v18, vcc
    s_lshl_b32 s67, s50, 8
    s_add_u32 s67, s67, 8781824
    v_lshrrev_b32 v11, 5, v0
    v_lshlrev_b32 v11, 10, v11
    v_add_u32 v11, s67, v11
    v_mov_b32 v27, v11
    s_lshr_b32 s67, s68, 1
    s_lshl_b32 s67, s67, 3
    s_add_u32 s67, s67, s50
    s_lshl_b32 s67, s67, 8
    s_add_u32 s67, s67, 8798208
    v_writelane_b32 v11, s67, 0
    s_add_u32 s67, s67, 1024
    v_writelane_b32 v11, s67, 1
    s_lshr_b32 s67, s68, 3
    s_add_u32 s67, s67, 2
    s_bfe_u32 s67, s67, 0x10002
    s_mul_i32 s67, s67, 20
    s_mul_i32 s70, s69, 5
    s_add_u32 s67, s67, s70
    s_lshl_b32 s67, s67, 8
    s_add_u32 s67, s67, 8784896
    v_mov_b32 v12, s67
    s_lshl_b32 s71, s66, 8
    s_add_u32 s67, s67, s71
    s_sub_u32 s67, s67, 1024
    v_writelane_b32 v12, s67, 0
    s_lshl_b32 s70, s70, 11
    s_add_u32 s100, s100, s70
    s_lshl_b32 s101, s66, 11
    s_and_b32 s70, s52, 1
    s_lshl_b32 s71, s54, 1
    s_add_u32 s70, s70, s71
    s_lshl_b32 s70, s70, 3
    s_add_u32 s70, s70, s50
    s_mul_i32 s70, s70, 25600
    s_add_u32 s2, s70, 7864320
    v_lshlrev_b32 v1, 4, v0
    s_waitcnt vmcnt(0)
    v_readfirstlane_b32 s73, v61
    s_nop 0
    s_cmp_lg_u32 s73, 127
    s_cbranch_scc1 Lda_24
    v_mov_b32 v61, 1
    s_mov_b64 exec, 1
    buffer_store_dword v61, v60, s[40:43], 0 offen offset:132 sc1
    s_mov_b64 exec, -1
Lda_24:
    s_barrier
    s_cmp_lg_u32 s50, 7
    s_cbranch_scc1 Lc7
    s_setprio 3
    v_mov_b32 v61, 1
    s_mov_b64 exec, 1
    buffer_atomic_add v61, v60, s[40:43], 0 offen offset:0 sc0 sc1
    s_mov_b64 exec, -1
    s_lshl_b32 s67, s76, 2
    s_lshr_b32 s70, s50, 1
    s_and_b32 s71, s50, 1
    s_lshl_b32 s71, s71, 11
    s_add_u32 s72, s67, s70
    s_lshl_b32 s72, s72, 12
    s_add_u32 s72, s72, s71
    s_mul_i32 s70, s70, 4224
    s_add_u32 s70, s70, s71
    s_add_u32 m0, s70, 129152
    s_nop 0
    buffer_load_dwordx4 v1, s[28:31], s72 offen lds
    buffer_load_dwordx4 v1, s[28:31], s72 offen offset:1024 lds
    s_waitcnt lgkmcnt(0)
    s_and_b32 s70, s63, 1
    s_lshl_b32 s70, s70, 4
    s_lshr_b32 s77, s77, s70
    s_and_b32 s77, s77, 0xffff
    v_lshlrev_b32 v98, 2, v0
    v_and_b32 v98, 16, v98
    v_lshlrev_b32 v98, v98, s77
    v_and_b32 v99, 59, v0
    v_cmp_eq_u32 vcc, 32, v99
    s_nop 1
    v_cndmask_b32 v144, 0, v98, vcc
    v_cmp_eq_u32 vcc, 40, v99
    s_nop 1
    v_cndmask_b32 v145, 0, v98, vcc
    v_cmp_eq_u32 vcc, 48, v99
    s_nop 1
    v_cndmask_b32 v146, 0, v98, vcc
    v_cmp_eq_u32 vcc, 56, v99
    s_nop 1
    v_cndmask_b32 v147, 0, v98, vcc
    s_waitcnt vmcnt(2)
    v_readfirstlane_b32 s73, v61
    s_nop 0
    s_cmp_lg_u32 s73, 63
    s_cbranch_scc1 Lda_25
    v_mov_b32 v61, 1
    s_mov_b64 exec, 1
    buffer_store_dword v61, v60, s[40:43], 0 offen offset:128 sc1
    s_mov_b64 exec, -1
Lda_25:
    v_and_b32 v44, 1, v0
    v_lshl_add_u32 v44, v44, 2, 64
    v_add_u32 v44, 64, v44
    s_mov_b32 s56, 0x20000
Lpoll_26:
    buffer_load_dword v46, v44, s[40:43], 0 offen sc1
    s_waitcnt vmcnt(0)
    v_cmp_ne_u32 vcc, s55, v46
    s_cbranch_vccz Lpd_27
    s_sleep 2
    s_sub_u32 s56, s56, 1
    s_cbranch_scc0 Lpoll_26
Lpd_27:
    s_lshl_b32 s71, s59, 14
    s_mov_b32 m0, 112640
    s_nop 0
    buffer_load_dwordx4 v1, s[44:47], s71 offen offset:0 sc1 lds
    buffer_load_dwordx4 v1, s[44:47], s71 offen offset:1024 sc1 lds
    buffer_load_dwordx4 v1, s[44:47], s71 offen offset:2048 sc1 lds
    buffer_load_dwordx4 v1, s[44:47], s71 offen offset:3072 sc1 lds
    s_add_u32 s71, s71, 4096
    s_mov_b32 m0, 116736
    s_nop 0
    buffer_load_dwordx4 v1, s[44:47], s71 offen offset:0 sc1 lds
    buffer_load_dwordx4 v1, s[44:47], s71 offen offset:1024 sc1 lds
    buffer_load_dwordx4 v1, s[44:47], s71 offen offset:2048 sc1 lds
    buffer_load_dwordx4 v1, s[44:47], s71 offen offset:3072 sc1 lds
    s_add_u32 s71, s71, 4096
    s_mov_b32 m0, 120832
    s_nop 0
    buffer_load_dwordx4 v1, s[44:47], s71 offen offset:0 sc1 lds
    buffer_load_dwordx4 v1, s[44:47], s71 offen offset:1024 sc1 lds
    buffer_load_dwordx4 v1, s[44:47], s71 offen offset:2048 sc1 lds
    buffer_load_dwordx4 v1, s[44:47], s71 offen offset:3072 sc1 lds
    s_add_u32 s71, s71, 4096
    s_mov_b32 m0, 124928
    s_nop 0
    buffer_load_dwordx4 v1, s[44:47], s71 offen offset:0 sc1 lds
    buffer_load_dwordx4 v1, s[44:47], s71 offen offset:1024 sc1 lds
    buffer_load_dwordx4 v1, s[44:47], s71 offen offset:2048 sc1 lds
    buffer_load_dwordx4 v1, s[44:47], s71 offen offset:3072 sc1 lds
    s_branch Lc8
Lcjoin:
    s_mov_b32 s6, 2621440
    s_mov_b32 s7, 0x20000
    s_mov_b32 s30, 2621440
    s_mov_b32 s31, 0x20000
    s_mov_b32 s42, 256
    s_mov_b32 s43, 0x20000
    s_mov_b32 s38, 2621440
    s_mov_b32 s39, 0x20000
    s_waitcnt vmcnt(0)
    s_barrier
    v_mov_b32 v100, 0
    v_mov_b32 v101, 0
    v_lshlrev_b32 v102, 3, v0
    s_and_b32 s72, s50, 3
    s_lshl_b32 s70, s72, 9
    s_add_u32 s70, s70, 110592
    v_add_u32 v103, s70, v102
    ds_write_b64 v103, v[100:101]
    s_mul_i32 s70, s72, 4224
    s_add_u32 s70, s70, 129024
    v_add_u32 v103, s70, v102
    s_mov_b64 exec, 0xffff
    ds_write_b64 v103, v[100:101]
    v_add_u32 v103, 146048, v102
    s_mov_b64 exec, 0xff
    ds_write_b64 v103, v[100:101]
    s_mov_b64 exec, -1
    s_mov_b32 s67, 0
    s_lshr_b32 s61, s50, 1
    s_and_b32 s62, s50, 1
    s_add_u32 s60, s67, s61
    s_lshl_b32 s63, s59, 2
    s_add_u32 s63, s63, s60
    s_lshl_b32 s70, s63, 1
    s_and_b32 s70, s70, -4
    s_load_dword s77, s[48:49], s70
    v_and_b32 v96, 31, v0
    v_lshrrev_b32 v97, 5, v0
    v_lshl_add_u32 v98, v97, 2, v96
    v_lshrrev_b32 v99, 2, v98
    v_add_u32 v99, 3, v99
    v_and_b32 v99, 3, v99
    v_xor_b32 v99, s60, v99
    v_lshlrev_b32 v99, 4, v99
    v_lshl_add_u32 v99, v98, 6, v99
    v_add_u32 v148, 110848, v99
    v_xor_b32 v149, 32, v148
    v_bfe_u32 v98, v0, 4, 1
    v_and_b32 v99, 3, v0
    v_lshl_add_u32 v98, v98, 2, v99
    v_bfe_u32 v96, v0, 2, 2
    v_sub_u32 v98, v98, v96
    v_lshlrev_b32 v97, 3, v97
    v_sub_u32 v98, v98, v97
    v_lshlrev_b32 v98, 3, v98
    s_mul_i32 s70, s61, 4224
    s_add_u32 s70, s70, 129184
    v_add_u32 v150, s70, v98
    s_lshl_b32 s70, s50, 11
    s_add_u32 s70, s70, 92160
    v_lshlrev_b32 v151, 4, v0
    v_add_u32 v151, s70, v151
    v_lshrrev_b32 v97, 4, v0
    v_lshrrev_b32 v98, 1, v99
    v_lshl_add_u32 v98, v97, 1, v98
    v_lshl_add_u32 v98, v98, 3, v96
    v_lshlrev_b32 v98, 4, v98
    v_and_b32 v99, 1, v99
    v_lshl_add_u32 v98, v99, 3, v98
    v_add_u32 v152, s70, v98
    v_and_b32 v98, 7, v0
    v_lshrrev_b32 v99, 5, v0
    v_lshl_add_u32 v98, v98, 1, v99
    v_mul_u32_u24 v98, 40960, v98
    v_bfe_u32 v99, v0, 3, 2
    v_lshl_add_u32 v154, v99, 4, v98
    s_lshl_b32 s70, s50, 4
    s_add_u32 s70, s70, 145920
    v_mov_b32 v153, s70
    s_lshl_b32 s70, s61, 2
    s_add_u32 s70, s70, 146064
    v_mov_b32 v155, s70
    s_lshr_b32 s66, s52, 1
    s_lshl_b32 s68, s53, 4
    s_add_u32 s68, s68, s66
    s_and_b32 s66, s52, 1
    s_lshl_b32 s69, s54, 1
    s_add_u32 s69, s69, s66
    v_lshlrev_b32 v1, 4, v0
    v_mov_b32 v13, 0
    v_and_b32 v24, 31, v0
    v_lshrrev_b32 v25, 5, v0
    s_and_b32 s66, s50, 3
    s_lshl_b32 s67, s66, 6
    s_lshl_b32 s70, s66, 4
    s_add_u32 s70, s70, 256
    s_cmp_lt_u32 s50, 4
    s_cselect_b32 s67, s67, s70
    s_cselect_b32 s71, 4, 3
    v_mul_u32_u24 v14, 1280, v24
    v_lshl_add_u32 v14, v25, s71, v14
    s_mul_i32 s96, s68, 40960
    s_mul_i32 s70, s69, 320
    s_add_u32 s100, s96, 5242880
    s_add_u32 s96, s96, s70
    s_add_u32 s96, s96, s67
    s_lshl_b32 s71, s68, 7
    s_add_u32 s71, s71, 8962048
    v_lshlrev_b32 v19, 2, v24
    v_add_u32 v19, s71, v19
    v_bfe_u32 v26, v0, 2, 2
    v_lshl_add_u32 v26, v25, 2, v26
    v_lshlrev_b32 v17, 6, v26
    v_bfe_u32 v26, v0, 4, 1
    v_lshl_add_u32 v17, v26, 5, v17
    v_and_b32 v26, 3, v0
    v_lshl_add_u32 v17, v26, 3, v17
    s_lshl_b32 s67, s67, 5
    s_add_u32 s67, s67, 146176
    v_add_u32 v17, s67, v17
    s_lshl_b32 s67, s66, 12
    s_add_u32 s67, s67, 77824
    v_add_u32 v5, s67, v1
    s_lshl_b32 s67, s66, 10
    s_add_u32 s67, s67, 94208
    v_add_u32 v15, s67, v1
    s_mul_i32 s67, s66, 10240
    s_add_u32 s67, s67, 36864
    v_add_u32 v4, s67, v1
    v_add_u32 v3, 36864, v1
    s_mul_i32 s67, s50, 5120
    s_add_u32 s70, s67, 36864
    v_add_u32 v2, s70, v1
    s_add_u32 s97, s100, s67
    s_add_u32 s97, s97, 4292345856
    v_mul_u32_u24 v25, 336, v25
    v_min_u32 v26, 20, v24
    v_lshl_add_u32 v26, v26, 4, v25
    v_lshrrev_b32 v27, 2, v24
    v_mov_b32 v18, 0x7f000000
    v_cmp_eq_u32 vcc, 5, v27
    v_subrev_u32 v10, 4, v24
    v_lshl_add_u32 v10, v10, 4, v25
    v_cndmask_b32 v9, v26, v18, vcc
    v_cndmask_b32 v10, v26, v10, vcc
    v_cmp_eq_u32 vcc, 4, v27
    s_mul_i32 s98, s50, 7168
    s_add_u32 s98, s98, 8716288
    v_cndmask_b32 v10, v10, v18, vcc
    s_lshl_b32 s67, s50, 8
    s_add_u32 s67, s67, 8781824
    v_lshrrev_b32 v11, 5, v0
    v_lshlrev_b32 v11, 10, v11
    v_add_u32 v11, s67, v11
    v_mov_b32 v27, v11
    s_lshr_b32 s67, s68, 1
    s_lshl_b32 s67, s67, 3
    s_add_u32 s67, s67, s50
    s_lshl_b32 s67, s67, 8
    s_add_u32 s67, s67, 8798208
    v_writelane_b32 v11, s67, 0
    s_add_u32 s67, s67, 1024
    v_writelane_b32 v11, s67, 1
    s_lshr_b32 s67, s68, 3
    s_add_u32 s67, s67, 2
    s_bfe_u32 s67, s67, 0x10002
    s_mul_i32 s67, s67, 20
    s_mul_i32 s70, s69, 5
    s_add_u32 s67, s67, s70
    s_lshl_b32 s67, s67, 8
    s_add_u32 s67, s67, 8784896
    v_mov_b32 v12, s67
    s_lshl_b32 s71, s66, 8
    s_add_u32 s67, s67, s71
    s_sub_u32 s67, s67, 1024
    v_writelane_b32 v12, s67, 0
    s_lshl_b32 s70, s70, 11
    s_add_u32 s100, s100, s70
    s_lshl_b32 s101, s66, 11
    s_and_b32 s70, s52, 1
    s_lshl_b32 s71, s54, 1
    s_add_u32 s70, s70, s71
    s_lshl_b32 s70, s70, 3
    s_add_u32 s70, s70, s50
    s_mul_i32 s70, s70, 25600
    s_add_u32 s2, s70, 7864320
    v_lshlrev_b32 v1, 4, v0
Lc7:
    s_lshl_b32 s67, s76, 2
    s_lshr_b32 s70, s50, 1
    s_and_b32 s71, s50, 1
    s_lshl_b32 s71, s71, 11
    s_add_u32 s72, s67, s70
    s_lshl_b32 s72, s72, 12
    s_add_u32 s72, s72, s71
    s_mul_i32 s70, s70, 4224
    s_add_u32 s70, s70, s71
    s_add_u32 m0, s70, 129152
    s_nop 0
    buffer_load_dwordx4 v1, s[28:31], s72 offen lds
    buffer_load_dwordx4 v1, s[28:31], s72 offen offset:1024 lds
    s_waitcnt lgkmcnt(0)
    s_and_b32 s70, s63, 1
    s_lshl_b32 s70, s70, 4
    s_lshr_b32 s77, s77, s70
    s_and_b32 s77, s77, 0xffff
    v_lshlrev_b32 v98, 2, v0
    v_and_b32 v98, 16, v98
    v_lshlrev_b32 v98, v98, s77
    v_and_b32 v99, 59, v0
    v_cmp_eq_u32 vcc, 32, v99
    s_nop 1
    v_cndmask_b32 v144, 0, v98, vcc
    v_cmp_eq_u32 vcc, 40, v99
    s_nop 1
    v_cndmask_b32 v145, 0, v98, vcc
    v_cmp_eq_u32 vcc, 48, v99
    s_nop 1
    v_cndmask_b32 v146, 0, v98, vcc
    v_cmp_eq_u32 vcc, 56, v99
    s_nop 1
    v_cndmask_b32 v147, 0, v98, vcc
Lc8:
    s_waitcnt vmcnt(0) lgkmcnt(0)
    s_barrier
    s_setprio 2
    s_cmp_lt_u32 s50, 4
    s_cbranch_scc1 Lconv2
    s_setprio 0
    buffer_load_dwordx4 v[156:159], v1, s[44:47], s2 offen offset:0 sc1
    buffer_load_dwordx4 v[160:163], v1, s[44:47], s2 offen offset:1024 sc1
    buffer_load_dwordx4 v[164:167], v1, s[44:47], s2 offen offset:2048 sc1
    buffer_load_dwordx4 v[168:171], v1, s[44:47], s2 offen offset:3072 sc1
    s_add_u32 s2, s2, 4096
    buffer_load_dwordx4 v[172:175], v1, s[44:47], s2 offen offset:0 sc1
    buffer_load_dwordx4 v[176:179], v1, s[44:47], s2 offen offset:1024 sc1
    buffer_load_dwordx4 v[180:183], v1, s[44:47], s2 offen offset:2048 sc1
    buffer_load_dwordx4 v[184:187], v1, s[44:47], s2 offen offset:3072 sc1
    s_add_u32 s2, s2, 4096
    buffer_load_dwordx4 v[188:191], v1, s[44:47], s2 offen offset:0 sc1
    buffer_load_dwordx4 v[192:195], v1, s[44:47], s2 offen offset:1024 sc1
    buffer_load_dwordx4 v[196:199], v1, s[44:47], s2 offen offset:2048 sc1
    buffer_load_dwordx4 v[200:203], v1, s[44:47], s2 offen offset:3072 sc1
    s_add_u32 s2, s2, 4096
    buffer_load_dwordx4 v[204:207], v1, s[44:47], s2 offen offset:0 sc1
    buffer_load_dwordx4 v[208:211], v1, s[44:47], s2 offen offset:1024 sc1
    buffer_load_dwordx4 v[212:215], v1, s[44:47], s2 offen offset:2048 sc1
    buffer_load_dwordx4 v[216:219], v1, s[44:47], s2 offen offset:3072 sc1
    s_add_u32 s2, s2, 4096
    buffer_load_dwordx4 v[220:223], v1, s[44:47], s2 offen offset:0 sc1
    buffer_load_dwordx4 v[224:227], v1, s[44:47], s2 offen offset:1024 sc1
    buffer_load_dwordx4 v[228:231], v1, s[44:47], s2 offen offset:2048 sc1
    buffer_load_dwordx4 v[232:235], v1, s[44:47], s2 offen offset:3072 sc1
    s_add_u32 s2, s2, 4096
    buffer_load_dwordx4 v[236:239], v1, s[44:47], s2 offen offset:0 sc1
    buffer_load_dwordx4 v[240:243], v1, s[44:47], s2 offen offset:1024 sc1
    buffer_load_dwordx4 v[244:247], v1, s[44:47], s2 offen offset:2048 sc1
    buffer_load_dwordx4 v[248:251], v1, s[44:47], s2 offen offset:3072 sc1
    s_add_u32 s2, s2, 4096
    buffer_load_dwordx4 v[252:255], v1, s[44:47], s2 offen offset:0 sc1
    s_cmp_ge_u32 s50, 4
    s_cbranch_scc1 Lxe_28
    buffer_load_dwordx4 v[20:23], v14, s[4:7], s96 offen
    buffer_load_dwordx4 v[28:31], v14, s[4:7], s96 offen offset:32
    s_branch Lxd_29
Lxe_28:
    buffer_load_dword v20, v14, s[4:7], s96 offen
    buffer_load_dword v21, v14, s[4:7], s96 offen offset:4
Lxd_29:
Lconv:
    s_setprio 1
Lconv2:
    s_cmp_eq_u32 s62, 1
    s_cbranch_scc1 Lconvy
    ds_read_b128 v[96:99], v148 offset:15872
    ds_read_b64_tr_b16 v[100:101], v150 offset:32
    ds_read_b64_tr_b16 v[102:103], v150 offset:0
    ds_read_b128 v[104:107], v148 offset:13824
    ds_read_b64_tr_b16 v[108:109], v150 offset:544
    ds_read_b64_tr_b16 v[110:111], v150 offset:512
    ds_read_b128 v[112:115], v148 offset:11776
    ds_read_b64_tr_b16 v[116:117], v150 offset:1056
    ds_read_b64_tr_b16 v[118:119], v150 offset:1024
    ds_read_b128 v[120:123], v148 offset:9728
    s_waitcnt lgkmcnt(7)
    v_mfma_f32_32x32x16_bf16 v[80:95], v[96:99], v[100:103], 0
    ds_read_b64_tr_b16 v[124:125], v150 offset:1568
    ds_read_b64_tr_b16 v[126:127], v150 offset:1536
    v_mfma_f32_32x32x16_bf16 v[80:95], v[96:99], v[144:147], v[80:95]
    ds_read_b128 v[128:131], v148 offset:7680
    ds_read_b64_tr_b16 v[132:133], v150 offset:2080
    ds_read_b64_tr_b16 v[134:135], v150 offset:2048
    s_waitcnt lgkmcnt(11)
    v_mfma_f32_32x32x16_bf16 v[64:79], v[104:107], v[100:103], 0
    ds_read_b128 v[136:139], v148 offset:5632
    ds_read_b64_tr_b16 v[140:141], v150 offset:2592
    ds_read_b64_tr_b16 v[142:143], v150 offset:2560
    v_mfma_f32_32x32x16_bf16 v[64:79], v[104:107], v[144:147], v[64:79]
    ds_read_b128 v[96:99], v148 offset:3584
    ds_read_b64_tr_b16 v[100:101], v150 offset:32
    ds_read_b64_tr_b16 v[102:103], v150 offset:0
    s_waitcnt lgkmcnt(15)
    v_mfma_f32_32x32x16_bf16 v[80:95], v[104:107], v[108:111], v[80:95]
    ds_read_b64_tr_b16 v[104:105], v150 offset:3104
    ds_read_b64_tr_b16 v[106:107], v150 offset:3072
    s_waitcnt lgkmcnt(15)
    v_mfma_f32_32x32x16_bf16 v[64:79], v[112:115], v[108:111], v[64:79]
    ds_read_b128 v[108:111], v148 offset:1536
    s_waitcnt lgkmcnt(15)
    v_mfma_f32_32x32x16_bf16 v[80:95], v[112:115], v[116:119], v[80:95]
    ds_read_b64_tr_b16 v[112:113], v150 offset:544
    ds_read_b64_tr_b16 v[114:115], v150 offset:512
    s_waitcnt lgkmcnt(15)
    v_mfma_f32_32x32x16_bf16 v[64:79], v[120:123], v[116:119], v[64:79]
    ds_read_b64_tr_b16 v[116:117], v150 offset:3616
    ds_read_b64_tr_b16 v[118:119], v150 offset:3584
    s_waitcnt lgkmcnt(15)
    v_mfma_f32_32x32x16_bf16 v[80:95], v[120:123], v[124:127], v[80:95]
    ds_read_b128 v[120:123], v149 offset:15360
    v_mfma_f32_32x32x16_bf16 v[64:79], v[128:131], v[124:127], v[64:79]
    ds_read_b64_tr_b16 v[124:125], v150 offset:160
    ds_read_b64_tr_b16 v[126:127], v150 offset:128
    s_waitcnt lgkmcnt(15)
    v_mfma_f32_32x32x16_bf16 v[80:95], v[128:131], v[132:135], v[80:95]
    ds_read_b128 v[128:131], v149 offset:13312
    v_mfma_f32_32x32x16_bf16 v[64:79], v[136:139], v[132:135], v[64:79]
    ds_read_b64_tr_b16 v[132:133], v150 offset:672
    ds_read_b64_tr_b16 v[134:135], v150 offset:640
    s_waitcnt lgkmcnt(15)
    v_mfma_f32_32x32x16_bf16 v[80:95], v[136:139], v[140:143], v[80:95]
    ds_read_b128 v[136:139], v149 offset:11264
    v_mfma_f32_32x32x16_bf16 v[64:79], v[96:99], v[140:143], v[64:79]
    ds_read_b64_tr_b16 v[140:141], v150 offset:1184
    ds_read_b64_tr_b16 v[142:143], v150 offset:1152
    s_waitcnt lgkmcnt(15)
    v_mfma_f32_32x32x16_bf16 v[48:63], v[96:99], v[100:103], 0
    v_mfma_f32_32x32x16_bf16 v[48:63], v[96:99], v[144:147], v[48:63]
    s_waitcnt lgkmcnt(14)
    v_mfma_f32_32x32x16_bf16 v[80:95], v[96:99], v[104:107], v[80:95]
    ds_read_b128 v[96:99], v149 offset:9216
    s_waitcnt lgkmcnt(14)
    v_mfma_f32_32x32x16_bf16 v[64:79], v[108:111], v[104:107], v[64:79]
    ds_read_b64_tr_b16 v[104:105], v150 offset:1696
    ds_read_b64_tr_b16 v[106:107], v150 offset:1664
    v_mfma_f32_32x32x16_bf16 v[32:47], v[108:111], v[100:103], 0
    ds_read_b128 v[100:103], v149 offset:7168
    v_mfma_f32_32x32x16_bf16 v[32:47], v[108:111], v[144:147], v[32:47]
    s_waitcnt lgkmcnt(15)
    v_mfma_f32_32x32x16_bf16 v[48:63], v[108:111], v[112:115], v[48:63]
    ds_read_b64_tr_b16 v[112:113], v150 offset:2208
    ds_read_b64_tr_b16 v[114:115], v150 offset:2176
    s_waitcnt lgkmcnt(15)
    v_mfma_f32_32x32x16_bf16 v[80:95], v[108:111], v[116:119], v[80:95]
    ds_read_b128 v[108:111], v149 offset:5120
    ds_read_b64_tr_b16 v[116:117], v150 offset:2720
    ds_read_b64_tr_b16 v[118:119], v150 offset:2688
    s_waitcnt lgkmcnt(15)
    v_mfma_f32_32x32x16_bf16 v[80:95], v[120:123], v[124:127], v[80:95]
    ds_read_b128 v[120:123], v149 offset:3072
    s_waitcnt lgkmcnt(15)
    v_mfma_f32_32x32x16_bf16 v[64:79], v[128:131], v[124:127], v[64:79]
    ds_read_b64_tr_b16 v[124:125], v150 offset:160
    ds_read_b64_tr_b16 v[126:127], v150 offset:128
    s_waitcnt lgkmcnt(15)
    v_mfma_f32_32x32x16_bf16 v[80:95], v[128:131], v[132:135], v[80:95]
    ds_read_b64_tr_b16 v[128:129], v150 offset:3232
    ds_read_b64_tr_b16 v[130:131], v150 offset:3200
    s_waitcnt lgkmcnt(15)
    v_mfma_f32_32x32x16_bf16 v[64:79], v[136:139], v[132:135], v[64:79]
    ds_read_b128 v[132:135], v149 offset:1024
    s_waitcnt lgkmcnt(15)
    v_mfma_f32_32x32x16_bf16 v[80:95], v[136:139], v[140:143], v[80:95]
    ds_read_b64_tr_b16 v[136:137], v150 offset:672
    ds_read_b64_tr_b16 v[138:139], v150 offset:640
    s_waitcnt lgkmcnt(15)
    v_mfma_f32_32x32x16_bf16 v[64:79], v[96:99], v[140:143], v[64:79]
    ds_read_b64_tr_b16 v[140:141], v150 offset:3744
    ds_read_b64_tr_b16 v[142:143], v150 offset:3712
    s_waitcnt lgkmcnt(15)
    v_mfma_f32_32x32x16_bf16 v[80:95], v[96:99], v[104:107], v[80:95]
    ds_read_b128 v[96:99], v148 offset:14848
    v_mfma_f32_32x32x16_bf16 v[64:79], v[100:103], v[104:107], v[64:79]
    ds_read_b64_tr_b16 v[104:105], v150 offset:288
    ds_read_b64_tr_b16 v[106:107], v150 offset:256
    s_waitcnt lgkmcnt(15)
    v_mfma_f32_32x32x16_bf16 v[80:95], v[100:103], v[112:115], v[80:95]
    ds_read_b128 v[100:103], v148 offset:12800
    v_mfma_f32_32x32x16_bf16 v[64:79], v[108:111], v[112:115], v[64:79]
    ds_read_b64_tr_b16 v[112:113], v150 offset:800
    ds_read_b64_tr_b16 v[114:115], v150 offset:768
    s_waitcnt lgkmcnt(15)
    v_mfma_f32_32x32x16_bf16 v[80:95], v[108:111], v[116:119], v[80:95]
    ds_read_b128 v[108:111], v148 offset:10752
    v_mfma_f32_32x32x16_bf16 v[64:79], v[120:123], v[116:119], v[64:79]
    ds_read_b64_tr_b16 v[116:117], v150 offset:1312
    ds_read_b64_tr_b16 v[118:119], v150 offset:1280
    s_waitcnt lgkmcnt(15)
    v_mfma_f32_32x32x16_bf16 v[48:63], v[120:123], v[124:127], v[48:63]
    s_waitcnt lgkmcnt(14)
    v_mfma_f32_32x32x16_bf16 v[80:95], v[120:123], v[128:131], v[80:95]
    ds_read_b128 v[120:123], v148 offset:8704
    s_waitcnt lgkmcnt(14)
    v_mfma_f32_32x32x16_bf16 v[64:79], v[132:135], v[128:131], v[64:79]
    ds_read_b64_tr_b16 v[128:129], v150 offset:1824
    ds_read_b64_tr_b16 v[130:131], v150 offset:1792
    v_mfma_f32_32x32x16_bf16 v[32:47], v[132:135], v[124:127], v[32:47]
    ds_read_b128 v[124:127], v148 offset:6656
    s_waitcnt lgkmcnt(15)
    v_mfma_f32_32x32x16_bf16 v[48:63], v[132:135], v[136:139], v[48:63]
    ds_read_b64_tr_b16 v[136:137], v150 offset:2336
    ds_read_b64_tr_b16 v[138:139], v150 offset:2304
    s_waitcnt lgkmcnt(15)
    v_mfma_f32_32x32x16_bf16 v[80:95], v[132:135], v[140:143], v[80:95]
    ds_read_b128 v[132:135], v148 offset:4608
    ds_read_b64_tr_b16 v[140:141], v150 offset:2848
    ds_read_b64_tr_b16 v[142:143], v150 offset:2816
    s_waitcnt lgkmcnt(15)
    v_mfma_f32_32x32x16_bf16 v[80:95], v[96:99], v[104:107], v[80:95]
    ds_read_b128 v[96:99], v148 offset:2560
    s_waitcnt lgkmcnt(15)
    v_mfma_f32_32x32x16_bf16 v[64:79], v[100:103], v[104:107], v[64:79]
    ds_read_b64_tr_b16 v[104:105], v150 offset:288
    ds_read_b64_tr_b16 v[106:107], v150 offset:256
    s_waitcnt lgkmcnt(15)
    v_mfma_f32_32x32x16_bf16 v[80:95], v[100:103], v[112:115], v[80:95]
    ds_read_b64_tr_b16 v[100:101], v150 offset:3360
    ds_read_b64_tr_b16 v[102:103], v150 offset:3328
    s_waitcnt lgkmcnt(15)
    v_mfma_f32_32x32x16_bf16 v[64:79], v[108:111], v[112:115], v[64:79]
    ds_read_b128 v[112:115], v148 offset:512
    s_waitcnt lgkmcnt(15)
    v_mfma_f32_32x32x16_bf16 v[80:95], v[108:111], v[116:119], v[80:95]
    ds_read_b64_tr_b16 v[108:109], v150 offset:800
    ds_read_b64_tr_b16 v[110:111], v150 offset:768
    s_waitcnt lgkmcnt(15)
    v_mfma_f32_32x32x16_bf16 v[64:79], v[120:123], v[116:119], v[64:79]
    ds_read_b64_tr_b16 v[116:117], v150 offset:3872
    ds_read_b64_tr_b16 v[118:119], v150 offset:3840
    s_waitcnt lgkmcnt(15)
    v_mfma_f32_32x32x16_bf16 v[80:95], v[120:123], v[128:131], v[80:95]
    ds_read_b128 v[120:123], v149 offset:14336
    v_mfma_f32_32x32x16_bf16 v[64:79], v[124:127], v[128:131], v[64:79]
    ds_read_b64_tr_b16 v[128:129], v150 offset:416
    ds_read_b64_tr_b16 v[130:131], v150 offset:384
    s_waitcnt lgkmcnt(15)
    v_mfma_f32_32x32x16_bf16 v[80:95], v[124:127], v[136:139], v[80:95]
    ds_read_b128 v[124:127], v149 offset:12288
    v_mfma_f32_32x32x16_bf16 v[64:79], v[132:135], v[136:139], v[64:79]
    ds_read_b64_tr_b16 v[136:137], v150 offset:928
    ds_read_b64_tr_b16 v[138:139], v150 offset:896
    s_waitcnt lgkmcnt(15)
    v_mfma_f32_32x32x16_bf16 v[80:95], v[132:135], v[140:143], v[80:95]
    ds_read_b128 v[132:135], v149 offset:10240
    v_mfma_f32_32x32x16_bf16 v[64:79], v[96:99], v[140:143], v[64:79]
    ds_read_b64_tr_b16 v[140:141], v150 offset:1440
    ds_read_b64_tr_b16 v[142:143], v150 offset:1408
    s_waitcnt lgkmcnt(15)
    v_mfma_f32_32x32x16_bf16 v[48:63], v[96:99], v[104:107], v[48:63]
    s_waitcnt lgkmcnt(14)
    v_mfma_f32_32x32x16_bf16 v[80:95], v[96:99], v[100:103], v[80:95]
    ds_read_b128 v[96:99], v149 offset:8192
    s_waitcnt lgkmcnt(14)
    v_mfma_f32_32x32x16_bf16 v[64:79], v[112:115], v[100:103], v[64:79]
    ds_read_b64_tr_b16 v[100:101], v150 offset:1952
    ds_read_b64_tr_b16 v[102:103], v150 offset:1920
    v_mfma_f32_32x32x16_bf16 v[32:47], v[112:115], v[104:107], v[32:47]
    ds_read_b128 v[104:107], v149 offset:6144
    s_waitcnt lgkmcnt(15)
    v_mfma_f32_32x32x16_bf16 v[48:63], v[112:115], v[108:111], v[48:63]
    ds_read_b64_tr_b16 v[108:109], v150 offset:2464
    ds_read_b64_tr_b16 v[110:111], v150 offset:2432
    s_waitcnt lgkmcnt(15)
    v_mfma_f32_32x32x16_bf16 v[80:95], v[112:115], v[116:119], v[80:95]
    ds_read_b128 v[112:115], v149 offset:4096
    ds_read_b64_tr_b16 v[116:117], v150 offset:2976
    ds_read_b64_tr_b16 v[118:119], v150 offset:2944
    s_waitcnt lgkmcnt(15)
    v_mfma_f32_32x32x16_bf16 v[80:95], v[120:123], v[128:131], v[80:95]
    ds_read_b128 v[120:123], v149 offset:2048
    s_waitcnt lgkmcnt(15)
    v_mfma_f32_32x32x16_bf16 v[64:79], v[124:127], v[128:131], v[64:79]
    ds_read_b64_tr_b16 v[128:129], v150 offset:416
    ds_read_b64_tr_b16 v[130:131], v150 offset:384
    s_waitcnt lgkmcnt(15)
    v_mfma_f32_32x32x16_bf16 v[80:95], v[124:127], v[136:139], v[80:95]
    ds_read_b64_tr_b16 v[124:125], v150 offset:3488
    ds_read_b64_tr_b16 v[126:127], v150 offset:3456
    s_waitcnt lgkmcnt(15)
    v_mfma_f32_32x32x16_bf16 v[64:79], v[132:135], v[136:139], v[64:79]
    ds_read_b128 v[136:139], v149 offset:0
    s_waitcnt lgkmcnt(15)
    v_mfma_f32_32x32x16_bf16 v[80:95], v[132:135], v[140:143], v[80:95]
    ds_read_b64_tr_b16 v[132:133], v150 offset:928
    ds_read_b64_tr_b16 v[134:135], v150 offset:896
    s_waitcnt lgkmcnt(15)
    v_mfma_f32_32x32x16_bf16 v[64:79], v[96:99], v[140:143], v[64:79]
    ds_read_b64_tr_b16 v[140:141], v150 offset:4000
    ds_read_b64_tr_b16 v[142:143], v150 offset:3968
    s_waitcnt lgkmcnt(15)
    v_mfma_f32_32x32x16_bf16 v[80:95], v[96:99], v[100:103], v[80:95]
    v_mfma_f32_32x32x16_bf16 v[64:79], v[104:107], v[100:103], v[64:79]
    s_waitcnt lgkmcnt(13)
    v_mfma_f32_32x32x16_bf16 v[80:95], v[104:107], v[108:111], v[80:95]
    s_waitcnt lgkmcnt(12)
    v_mfma_f32_32x32x16_bf16 v[64:79], v[112:115], v[108:111], v[64:79]
    s_waitcnt lgkmcnt(10)
    v_mfma_f32_32x32x16_bf16 v[80:95], v[112:115], v[116:119], v[80:95]
    s_waitcnt lgkmcnt(9)
    v_mfma_f32_32x32x16_bf16 v[64:79], v[120:123], v[116:119], v[64:79]
    s_waitcnt lgkmcnt(7)
    v_mfma_f32_32x32x16_bf16 v[48:63], v[120:123], v[128:131], v[48:63]
    s_waitcnt lgkmcnt(5)
    v_mfma_f32_32x32x16_bf16 v[80:95], v[120:123], v[124:127], v[80:95]
    s_waitcnt lgkmcnt(4)
    v_mfma_f32_32x32x16_bf16 v[64:79], v[136:139], v[124:127], v[64:79]
    v_mfma_f32_32x32x16_bf16 v[32:47], v[136:139], v[128:131], v[32:47]
    s_waitcnt lgkmcnt(2)
    v_mfma_f32_32x32x16_bf16 v[48:63], v[136:139], v[132:135], v[48:63]
    s_waitcnt lgkmcnt(0)
    v_mfma_f32_32x32x16_bf16 v[80:95], v[136:139], v[140:143], v[80:95]
    s_setprio 3
    s_nop 7
    s_nop 3
    s_mov_b32 exec_lo, 0
    s_mov_b32 exec_hi, 0x80000000
    v_mov_b32 v98, v63
    v_mov_b32 v63, v59
    v_mov_b32 v59, v55
    v_mov_b32 v55, v51
    v_mov_b32 v51, v47
    v_mov_b32 v47, v43
    v_mov_b32 v43, v39
    v_mov_b32 v39, v35
    v_mov_b32 v35, 0
    v_mov_b32 v95, v91
    v_mov_b32 v91, v87
    v_mov_b32 v87, v83
    v_mov_b32 v83, v79
    v_mov_b32 v79, v75
    v_mov_b32 v75, v71
    v_mov_b32 v71, v67
    v_mov_b32 v67, 0
    s_mov_b64 exec, -1
    v_add_f32_dpp v94, v95, v94 wave_ror:1 row_mask:0xf bank_mask:0xf
    v_add_f32_dpp v90, v91, v90 wave_ror:1 row_mask:0xf bank_mask:0xf
    v_add_f32_dpp v86, v87, v86 wave_ror:1 row_mask:0xf bank_mask:0xf
    v_add_f32_dpp v82, v83, v82 wave_ror:1 row_mask:0xf bank_mask:0xf
    v_add_f32_dpp v78, v79, v78 wave_ror:1 row_mask:0xf bank_mask:0xf
    v_add_f32_dpp v74, v75, v74 wave_ror:1 row_mask:0xf bank_mask:0xf
    v_add_f32_dpp v70, v71, v70 wave_ror:1 row_mask:0xf bank_mask:0xf
    v_add_f32_dpp v66, v67, v66 wave_ror:1 row_mask:0xf bank_mask:0xf
    v_add_f32_dpp v62, v63, v62 wave_ror:1 row_mask:0xf bank_mask:0xf
    v_add_f32_dpp v58, v59, v58 wave_ror:1 row_mask:0xf bank_mask:0xf
    v_add_f32_dpp v54, v55, v54 wave_ror:1 row_mask:0xf bank_mask:0xf
    v_add_f32_dpp v50, v51, v50 wave_ror:1 row_mask:0xf bank_mask:0xf
    v_add_f32_dpp v46, v47, v46 wave_ror:1 row_mask:0xf bank_mask:0xf
    v_add_f32_dpp v42, v43, v42 wave_ror:1 row_mask:0xf bank_mask:0xf
    v_add_f32_dpp v38, v39, v38 wave_ror:1 row_mask:0xf bank_mask:0xf
    v_add_f32_dpp v34, v35, v34 wave_ror:1 row_mask:0xf bank_mask:0xf
    s_mov_b32 exec_lo, 0
    s_mov_b32 exec_hi, 0x80000000
    v_mov_b32 v97, v62
    v_mov_b32 v62, v58
    v_mov_b32 v58, v54
    v_mov_b32 v54, v50
    v_mov_b32 v50, v46
    v_mov_b32 v46, v42
    v_mov_b32 v42, v38
    v_mov_b32 v38, v34
    v_mov_b32 v34, 0
    v_mov_b32 v94, v90
    v_mov_b32 v90, v86
    v_mov_b32 v86, v82
    v_mov_b32 v82, v78
    v_mov_b32 v78, v74
    v_mov_b32 v74, v70
    v_mov_b32 v70, v66
    v_mov_b32 v66, 0
    s_mov_b64 exec, -1
    v_add_f32_dpp v93, v94, v93 wave_ror:1 row_mask:0xf bank_mask:0xf
    v_add_f32_dpp v89, v90, v89 wave_ror:1 row_mask:0xf bank_mask:0xf
    v_add_f32_dpp v85, v86, v85 wave_ror:1 row_mask:0xf bank_mask:0xf
    v_add_f32_dpp v81, v82, v81 wave_ror:1 row_mask:0xf bank_mask:0xf
    v_add_f32_dpp v77, v78, v77 wave_ror:1 row_mask:0xf bank_mask:0xf
    v_add_f32_dpp v73, v74, v73 wave_ror:1 row_mask:0xf bank_mask:0xf
    v_add_f32_dpp v69, v70, v69 wave_ror:1 row_mask:0xf bank_mask:0xf
    v_add_f32_dpp v65, v66, v65 wave_ror:1 row_mask:0xf bank_mask:0xf
    v_add_f32_dpp v61, v62, v61 wave_ror:1 row_mask:0xf bank_mask:0xf
    v_add_f32_dpp v57, v58, v57 wave_ror:1 row_mask:0xf bank_mask:0xf
    v_add_f32_dpp v53, v54, v53 wave_ror:1 row_mask:0xf bank_mask:0xf
    v_add_f32_dpp v49, v50, v49 wave_ror:1 row_mask:0xf bank_mask:0xf
    v_add_f32_dpp v45, v46, v45 wave_ror:1 row_mask:0xf bank_mask:0xf
    v_add_f32_dpp v41, v42, v41 wave_ror:1 row_mask:0xf bank_mask:0xf
    v_add_f32_dpp v37, v38, v37 wave_ror:1 row_mask:0xf bank_mask:0xf
    v_add_f32_dpp v33, v34, v33 wave_ror:1 row_mask:0xf bank_mask:0xf
    s_mov_b32 exec_lo, 0
    s_mov_b32 exec_hi, 0x80000000
    v_mov_b32 v96, v61
    v_mov_b32 v61, v57
    v_mov_b32 v57, v53
    v_mov_b32 v53, v49
    v_mov_b32 v49, v45
    v_mov_b32 v45, v41
    v_mov_b32 v41, v37
    v_mov_b32 v37, v33
    v_mov_b32 v33, 0
    v_mov_b32 v93, v89
    v_mov_b32 v89, v85
    v_mov_b32 v85, v81
    v_mov_b32 v81, v77
    v_mov_b32 v77, v73
    v_mov_b32 v73, v69
    v_mov_b32 v69, v65
    v_mov_b32 v65, 0
    ds_write_b96 v153, v[96:98]
    v_mov_b32 v100, 1
    ds_add_u32 v155, v100
    s_mov_b64 exec, -1
    v_add_f32_dpp v92, v93, v92 wave_ror:1 row_mask:0xf bank_mask:0xf
    v_add_f32_dpp v88, v89, v88 wave_ror:1 row_mask:0xf bank_mask:0xf
    v_add_f32_dpp v84, v85, v84 wave_ror:1 row_mask:0xf bank_mask:0xf
    v_add_f32_dpp v80, v81, v80 wave_ror:1 row_mask:0xf bank_mask:0xf
    v_add_f32_dpp v76, v77, v76 wave_ror:1 row_mask:0xf bank_mask:0xf
    v_add_f32_dpp v72, v73, v72 wave_ror:1 row_mask:0xf bank_mask:0xf
    v_add_f32_dpp v68, v69, v68 wave_ror:1 row_mask:0xf bank_mask:0xf
    v_add_f32_dpp v64, v65, v64 wave_ror:1 row_mask:0xf bank_mask:0xf
    v_add_f32_dpp v60, v61, v60 wave_ror:1 row_mask:0xf bank_mask:0xf
    v_add_f32_dpp v56, v57, v56 wave_ror:1 row_mask:0xf bank_mask:0xf
    v_add_f32_dpp v52, v53, v52 wave_ror:1 row_mask:0xf bank_mask:0xf
    v_add_f32_dpp v48, v49, v48 wave_ror:1 row_mask:0xf bank_mask:0xf
    v_add_f32_dpp v44, v45, v44 wave_ror:1 row_mask:0xf bank_mask:0xf
    v_add_f32_dpp v40, v41, v40 wave_ror:1 row_mask:0xf bank_mask:0xf
    v_add_f32_dpp v36, v37, v36 wave_ror:1 row_mask:0xf bank_mask:0xf
    v_add_f32_dpp v32, v33, v32 wave_ror:1 row_mask:0xf bank_mask:0xf
    v_xor_b32 v101, 16, v153
    v_lshl_add_u32 v101, v0, 2, v101
    v_cvt_pk_bf16_f32 v104, v32, v36
    v_cvt_pk_bf16_f32 v105, v40, v44
    v_cvt_pk_bf16_f32 v106, v48, v52
    v_cvt_pk_bf16_f32 v107, v56, v60
    v_cvt_pk_bf16_f32 v109, v72, v76
    v_cvt_pk_bf16_f32 v110, v80, v84
    v_cvt_pk_bf16_f32 v111, v88, v92
    ds_write_b128 v151, v[104:107] offset:0
    s_mov_b32 s56, 0x400000
Lls_30:
    ds_read_b32 v100, v155
    s_waitcnt lgkmcnt(0)
    v_readfirstlane_b32 s73, v100
    s_nop 0
    s_cmp_ge_u32 s73, 2
    s_cbranch_scc1 Lld_31
    s_sub_u32 s56, s56, 1
    s_cbranch_scc0 Lls_30
Lld_31:
    s_mov_b64 exec, 7
    ds_read_b32 v100, v101
    s_waitcnt lgkmcnt(0)
    v_add_f32 v64, v64, v100
    s_mov_b64 exec, -1
    v_cvt_pk_bf16_f32 v108, v64, v68
    ds_write_b128 v151, v[108:111] offset:1024
    s_lshl_b32 s71, s63, 6
    s_add_u32 s70, s71, 5242880
    s_add_u32 s71, s71, 7208960
    s_lshr_b32 s72, s63, 5
    s_lshl_b32 s72, s72, 8
    s_add_u32 s72, s72, 8783872
    s_branch Lconve
Lconvy:
    ds_read_b128 v[96:99], v148 offset:11776
    ds_read_b64_tr_b16 v[100:101], v150 offset:32
    ds_read_b64_tr_b16 v[102:103], v150 offset:0
    ds_read_b128 v[104:107], v148 offset:9728
    ds_read_b128 v[108:111], v148 offset:7680
    ds_read_b128 v[112:115], v148 offset:5632
    ds_read_b64_tr_b16 v[116:117], v150 offset:544
    ds_read_b64_tr_b16 v[118:119], v150 offset:512
    ds_read_b128 v[120:123], v148 offset:3584
    ds_read_b64_tr_b16 v[124:125], v150 offset:1056
    ds_read_b64_tr_b16 v[126:127], v150 offset:1024
    s_waitcnt lgkmcnt(8)
    v_mfma_f32_32x32x16_bf16 v[80:95], v[96:99], v[100:103], 0
    ds_read_b128 v[128:131], v148 offset:1536
    ds_read_b64_tr_b16 v[132:133], v150 offset:1568
    ds_read_b64_tr_b16 v[134:135], v150 offset:1536
    v_mfma_f32_32x32x16_bf16 v[80:95], v[96:99], v[144:147], v[80:95]
    ds_read_b64_tr_b16 v[136:137], v150 offset:2080
    ds_read_b64_tr_b16 v[138:139], v150 offset:2048
    s_waitcnt lgkmcnt(12)
    v_mfma_f32_32x32x16_bf16 v[64:79], v[104:107], v[100:103], 0
    ds_read_b64_tr_b16 v[140:141], v150 offset:2592
    ds_read_b64_tr_b16 v[142:143], v150 offset:2560
    v_mfma_f32_32x32x16_bf16 v[64:79], v[104:107], v[144:147], v[64:79]
    ds_read_b128 v[96:99], v149 offset:11264
    s_waitcnt lgkmcnt(14)
    v_mfma_f32_32x32x16_bf16 v[48:63], v[108:111], v[100:103], 0
    v_mfma_f32_32x32x16_bf16 v[48:63], v[108:111], v[144:147], v[48:63]
    s_waitcnt lgkmcnt(13)
    v_mfma_f32_32x32x16_bf16 v[32:47], v[112:115], v[100:103], 0
    ds_read_b64_tr_b16 v[100:101], v150 offset:160
    ds_read_b64_tr_b16 v[102:103], v150 offset:128
    v_mfma_f32_32x32x16_bf16 v[32:47], v[112:115], v[144:147], v[32:47]
    s_waitcnt lgkmcnt(13)
    v_mfma_f32_32x32x16_bf16 v[80:95], v[104:107], v[116:119], v[80:95]
    ds_read_b128 v[104:107], v149 offset:9216
    v_mfma_f32_32x32x16_bf16 v[64:79], v[108:111], v[116:119], v[64:79]
    v_mfma_f32_32x32x16_bf16 v[48:63], v[112:115], v[116:119], v[48:63]
    s_waitcnt lgkmcnt(13)
    v_mfma_f32_32x32x16_bf16 v[32:47], v[120:123], v[116:119], v[32:47]
    ds_read_b128 v[116:119], v149 offset:7168
    s_waitcnt lgkmcnt(12)
    v_mfma_f32_32x32x16_bf16 v[80:95], v[108:111], v[124:127], v[80:95]
    ds_read_b128 v[108:111], v149 offset:5120
    v_mfma_f32_32x32x16_bf16 v[64:79], v[112:115], v[124:127], v[64:79]
    v_mfma_f32_32x32x16_bf16 v[48:63], v[120:123], v[124:127], v[48:63]
    s_waitcnt lgkmcnt(12)
    v_mfma_f32_32x32x16_bf16 v[32:47], v[128:131], v[124:127], v[32:47]
    ds_read_b64_tr_b16 v[124:125], v150 offset:672
    ds_read_b64_tr_b16 v[126:127], v150 offset:640
    s_waitcnt lgkmcnt(12)
    v_mfma_f32_32x32x16_bf16 v[80:95], v[112:115], v[132:135], v[80:95]
    ds_read_b128 v[112:115], v149 offset:3072
    v_mfma_f32_32x32x16_bf16 v[64:79], v[120:123], v[132:135], v[64:79]
    v_mfma_f32_32x32x16_bf16 v[48:63], v[128:131], v[132:135], v[48:63]
    ds_read_b64_tr_b16 v[132:133], v150 offset:1184
    ds_read_b64_tr_b16 v[134:135], v150 offset:1152
    s_waitcnt lgkmcnt(13)
    v_mfma_f32_32x32x16_bf16 v[80:95], v[120:123], v[136:139], v[80:95]
    ds_read_b128 v[120:123], v149 offset:1024
    v_mfma_f32_32x32x16_bf16 v[64:79], v[128:131], v[136:139], v[64:79]
    ds_read_b64_tr_b16 v[136:137], v150 offset:1696
    ds_read_b64_tr_b16 v[138:139], v150 offset:1664
    s_waitcnt lgkmcnt(14)
    v_mfma_f32_32x32x16_bf16 v[80:95], v[128:131], v[140:143], v[80:95]
    ds_read_b64_tr_b16 v[128:129], v150 offset:2208
    ds_read_b64_tr_b16 v[130:131], v150 offset:2176
    s_waitcnt lgkmcnt(13)
    v_mfma_f32_32x32x16_bf16 v[80:95], v[96:99], v[100:103], v[80:95]
    ds_read_b64_tr_b16 v[140:141], v150 offset:2720
    ds_read_b64_tr_b16 v[142:143], v150 offset:2688
    s_waitcnt lgkmcnt(14)
    v_mfma_f32_32x32x16_bf16 v[64:79], v[104:107], v[100:103], v[64:79]
    ds_read_b128 v[96:99], v148 offset:10752
    s_waitcnt lgkmcnt(14)
    v_mfma_f32_32x32x16_bf16 v[48:63], v[116:119], v[100:103], v[48:63]
    s_waitcnt lgkmcnt(13)
    v_mfma_f32_32x32x16_bf16 v[32:47], v[108:111], v[100:103], v[32:47]
    ds_read_b64_tr_b16 v[100:101], v150 offset:288
    ds_read_b64_tr_b16 v[102:103], v150 offset:256
    s_waitcnt lgkmcnt(13)
    v_mfma_f32_32x32x16_bf16 v[80:95], v[104:107], v[124:127], v[80:95]
    ds_read_b128 v[104:107], v148 offset:8704
    v_mfma_f32_32x32x16_bf16 v[64:79], v[116:119], v[124:127], v[64:79]
    v_mfma_f32_32x32x16_bf16 v[48:63], v[108:111], v[124:127], v[48:63]
    s_waitcnt lgkmcnt(13)
    v_mfma_f32_32x32x16_bf16 v[32:47], v[112:115], v[124:127], v[32:47]
    ds_read_b128 v[124:127], v148 offset:6656
    s_waitcnt lgkmcnt(12)
    v_mfma_f32_32x32x16_bf16 v[80:95], v[116:119], v[132:135], v[80:95]
    ds_read_b128 v[116:119], v148 offset:4608
    v_mfma_f32_32x32x16_bf16 v[64:79], v[108:111], v[132:135], v[64:79]
    v_mfma_f32_32x32x16_bf16 v[48:63], v[112:115], v[132:135], v[48:63]
    s_waitcnt lgkmcnt(12)
    v_mfma_f32_32x32x16_bf16 v[32:47], v[120:123], v[132:135], v[32:47]
    ds_read_b64_tr_b16 v[132:133], v150 offset:800
    ds_read_b64_tr_b16 v[134:135], v150 offset:768
    s_waitcnt lgkmcnt(12)
    v_mfma_f32_32x32x16_bf16 v[80:95], v[108:111], v[136:139], v[80:95]
    ds_read_b128 v[108:111], v148 offset:2560
    v_mfma_f32_32x32x16_bf16 v[64:79], v[112:115], v[136:139], v[64:79]
    v_mfma_f32_32x32x16_bf16 v[48:63], v[120:123], v[136:139], v[48:63]
    ds_read_b64_tr_b16 v[136:137], v150 offset:1312
    ds_read_b64_tr_b16 v[138:139], v150 offset:1280
    s_waitcnt lgkmcnt(13)
    v_mfma_f32_32x32x16_bf16 v[80:95], v[112:115], v[128:131], v[80:95]
    ds_read_b128 v[112:115], v148 offset:512
    v_mfma_f32_32x32x16_bf16 v[64:79], v[120:123], v[128:131], v[64:79]
    ds_read_b64_tr_b16 v[128:129], v150 offset:1824
    ds_read_b64_tr_b16 v[130:131], v150 offset:1792
    s_waitcnt lgkmcnt(14)
    v_mfma_f32_32x32x16_bf16 v[80:95], v[120:123], v[140:143], v[80:95]
    ds_read_b64_tr_b16 v[120:121], v150 offset:2336
    ds_read_b64_tr_b16 v[122:123], v150 offset:2304
    s_waitcnt lgkmcnt(13)
    v_mfma_f32_32x32x16_bf16 v[80:95], v[96:99], v[100:103], v[80:95]
    ds_read_b64_tr_b16 v[140:141], v150 offset:2848
    ds_read_b64_tr_b16 v[142:143], v150 offset:2816
    s_waitcnt lgkmcnt(14)
    v_mfma_f32_32x32x16_bf16 v[64:79], v[104:107], v[100:103], v[64:79]
    ds_read_b128 v[96:99], v149 offset:10240
    s_waitcnt lgkmcnt(14)
    v_mfma_f32_32x32x16_bf16 v[48:63], v[124:127], v[100:103], v[48:63]
    s_waitcnt lgkmcnt(13)
    v_mfma_f32_32x32x16_bf16 v[32:47], v[116:119], v[100:103], v[32:47]
    ds_read_b64_tr_b16 v[100:101], v150 offset:416
    ds_read_b64_tr_b16 v[102:103], v150 offset:384
    s_waitcnt lgkmcnt(13)
    v_mfma_f32_32x32x16_bf16 v[80:95], v[104:107], v[132:135], v[80:95]
    ds_read_b128 v[104:107], v149 offset:8192
    v_mfma_f32_32x32x16_bf16 v[64:79], v[124:127], v[132:135], v[64:79]
    v_mfma_f32_32x32x16_bf16 v[48:63], v[116:119], v[132:135], v[48:63]
    s_waitcnt lgkmcnt(13)
    v_mfma_f32_32x32x16_bf16 v[32:47], v[108:111], v[132:135], v[32:47]
    ds_read_b128 v[132:135], v149 offset:6144
    s_waitcnt lgkmcnt(12)
    v_mfma_f32_32x32x16_bf16 v[80:95], v[124:127], v[136:139], v[80:95]
    ds_read_b128 v[124:127], v149 offset:4096
    v_mfma_f32_32x32x16_bf16 v[64:79], v[116:119], v[136:139], v[64:79]
    v_mfma_f32_32x32x16_bf16 v[48:63], v[108:111], v[136:139], v[48:63]
    s_waitcnt lgkmcnt(12)
    v_mfma_f32_32x32x16_bf16 v[32:47], v[112:115], v[136:139], v[32:47]
    ds_read_b64_tr_b16 v[136:137], v150 offset:928
    ds_read_b64_tr_b16 v[138:139], v150 offset:896
    s_waitcnt lgkmcnt(12)
    v_mfma_f32_32x32x16_bf16 v[80:95], v[116:119], v[128:131], v[80:95]
    ds_read_b128 v[116:119], v149 offset:2048
    v_mfma_f32_32x32x16_bf16 v[64:79], v[108:111], v[128:131], v[64:79]
    v_mfma_f32_32x32x16_bf16 v[48:63], v[112:115], v[128:131], v[48:63]
    ds_read_b64_tr_b16 v[128:129], v150 offset:1440
    ds_read_b64_tr_b16 v[130:131], v150 offset:1408
    s_waitcnt lgkmcnt(13)
    v_mfma_f32_32x32x16_bf16 v[80:95], v[108:111], v[120:123], v[80:95]
    ds_read_b128 v[108:111], v149 offset:0
    v_mfma_f32_32x32x16_bf16 v[64:79], v[112:115], v[120:123], v[64:79]
    ds_read_b64_tr_b16 v[120:121], v150 offset:1952
    ds_read_b64_tr_b16 v[122:123], v150 offset:1920
    s_waitcnt lgkmcnt(14)
    v_mfma_f32_32x32x16_bf16 v[80:95], v[112:115], v[140:143], v[80:95]
    ds_read_b64_tr_b16 v[112:113], v150 offset:2464
    ds_read_b64_tr_b16 v[114:115], v150 offset:2432
    s_waitcnt lgkmcnt(13)
    v_mfma_f32_32x32x16_bf16 v[80:95], v[96:99], v[100:103], v[80:95]
    ds_read_b64_tr_b16 v[140:141], v150 offset:2976
    ds_read_b64_tr_b16 v[142:143], v150 offset:2944
    s_waitcnt lgkmcnt(14)
    v_mfma_f32_32x32x16_bf16 v[64:79], v[104:107], v[100:103], v[64:79]
    s_waitcnt lgkmcnt(13)
    v_mfma_f32_32x32x16_bf16 v[48:63], v[132:135], v[100:103], v[48:63]
    s_waitcnt lgkmcnt(12)
    v_mfma_f32_32x32x16_bf16 v[32:47], v[124:127], v[100:103], v[32:47]
    s_waitcnt lgkmcnt(10)
    v_mfma_f32_32x32x16_bf16 v[80:95], v[104:107], v[136:139], v[80:95]
    v_mfma_f32_32x32x16_bf16 v[64:79], v[132:135], v[136:139], v[64:79]
    v_mfma_f32_32x32x16_bf16 v[48:63], v[124:127], v[136:139], v[48:63]
    s_waitcnt lgkmcnt(9)
    v_mfma_f32_32x32x16_bf16 v[32:47], v[116:119], v[136:139], v[32:47]
    s_waitcnt lgkmcnt(7)
    v_mfma_f32_32x32x16_bf16 v[80:95], v[132:135], v[128:131], v[80:95]
    v_mfma_f32_32x32x16_bf16 v[64:79], v[124:127], v[128:131], v[64:79]
    v_mfma_f32_32x32x16_bf16 v[48:63], v[116:119], v[128:131], v[48:63]
    s_waitcnt lgkmcnt(6)
    v_mfma_f32_32x32x16_bf16 v[32:47], v[108:111], v[128:131], v[32:47]
    s_waitcnt lgkmcnt(4)
    v_mfma_f32_32x32x16_bf16 v[80:95], v[124:127], v[120:123], v[80:95]
    v_mfma_f32_32x32x16_bf16 v[64:79], v[116:119], v[120:123], v[64:79]
    v_mfma_f32_32x32x16_bf16 v[48:63], v[108:111], v[120:123], v[48:63]
    s_waitcnt lgkmcnt(2)
    v_mfma_f32_32x32x16_bf16 v[80:95], v[116:119], v[112:115], v[80:95]
    v_mfma_f32_32x32x16_bf16 v[64:79], v[108:111], v[112:115], v[64:79]
    s_waitcnt lgkmcnt(0)
    v_mfma_f32_32x32x16_bf16 v[80:95], v[108:111], v[140:143], v[80:95]
    s_setprio 3
    s_nop 7
    s_nop 3
    s_mov_b32 exec_lo, 0
    s_mov_b32 exec_hi, 0x80000000
    v_mov_b32 v98, v95
    v_mov_b32 v95, v91
    v_mov_b32 v91, v87
    v_mov_b32 v87, v83
    v_mov_b32 v83, v79
    v_mov_b32 v79, v75
    v_mov_b32 v75, v71
    v_mov_b32 v71, v67
    v_mov_b32 v67, v63
    v_mov_b32 v63, v59
    v_mov_b32 v59, v55
    v_mov_b32 v55, v51
    v_mov_b32 v51, v47
    v_mov_b32 v47, v43
    v_mov_b32 v43, v39
    v_mov_b32 v39, v35
    v_mov_b32 v35, 0
    s_mov_b64 exec, -1
    v_add_f32_dpp v94, v95, v94 wave_ror:1 row_mask:0xf bank_mask:0xf
    v_add_f32_dpp v90, v91, v90 wave_ror:1 row_mask:0xf bank_mask:0xf
    v_add_f32_dpp v86, v87, v86 wave_ror:1 row_mask:0xf bank_mask:0xf
    v_add_f32_dpp v82, v83, v82 wave_ror:1 row_mask:0xf bank_mask:0xf
    v_add_f32_dpp v78, v79, v78 wave_ror:1 row_mask:0xf bank_mask:0xf
    v_add_f32_dpp v74, v75, v74 wave_ror:1 row_mask:0xf bank_mask:0xf
    v_add_f32_dpp v70, v71, v70 wave_ror:1 row_mask:0xf bank_mask:0xf
    v_add_f32_dpp v66, v67, v66 wave_ror:1 row_mask:0xf bank_mask:0xf
    v_add_f32_dpp v62, v63, v62 wave_ror:1 row_mask:0xf bank_mask:0xf
    v_add_f32_dpp v58, v59, v58 wave_ror:1 row_mask:0xf bank_mask:0xf
    v_add_f32_dpp v54, v55, v54 wave_ror:1 row_mask:0xf bank_mask:0xf
    v_add_f32_dpp v50, v51, v50 wave_ror:1 row_mask:0xf bank_mask:0xf
    v_add_f32_dpp v46, v47, v46 wave_ror:1 row_mask:0xf bank_mask:0xf
    v_add_f32_dpp v42, v43, v42 wave_ror:1 row_mask:0xf bank_mask:0xf
    v_add_f32_dpp v38, v39, v38 wave_ror:1 row_mask:0xf bank_mask:0xf
    v_add_f32_dpp v34, v35, v34 wave_ror:1 row_mask:0xf bank_mask:0xf
    s_mov_b32 exec_lo, 0
    s_mov_b32 exec_hi, 0x80000000
    v_mov_b32 v97, v94
    v_mov_b32 v94, v90
    v_mov_b32 v90, v86
    v_mov_b32 v86, v82
    v_mov_b32 v82, v78
    v_mov_b32 v78, v74
    v_mov_b32 v74, v70
    v_mov_b32 v70, v66
    v_mov_b32 v66, v62
    v_mov_b32 v62, v58
    v_mov_b32 v58, v54
    v_mov_b32 v54, v50
    v_mov_b32 v50, v46
    v_mov_b32 v46, v42
    v_mov_b32 v42, v38
    v_mov_b32 v38, v34
    v_mov_b32 v34, 0
    s_mov_b64 exec, -1
    v_add_f32_dpp v93, v94, v93 wave_ror:1 row_mask:0xf bank_mask:0xf
    v_add_f32_dpp v89, v90, v89 wave_ror:1 row_mask:0xf bank_mask:0xf
    v_add_f32_dpp v85, v86, v85 wave_ror:1 row_mask:0xf bank_mask:0xf
    v_add_f32_dpp v81, v82, v81 wave_ror:1 row_mask:0xf bank_mask:0xf
    v_add_f32_dpp v77, v78, v77 wave_ror:1 row_mask:0xf bank_mask:0xf
    v_add_f32_dpp v73, v74, v73 wave_ror:1 row_mask:0xf bank_mask:0xf
    v_add_f32_dpp v69, v70, v69 wave_ror:1 row_mask:0xf bank_mask:0xf
    v_add_f32_dpp v65, v66, v65 wave_ror:1 row_mask:0xf bank_mask:0xf
    v_add_f32_dpp v61, v62, v61 wave_ror:1 row_mask:0xf bank_mask:0xf
    v_add_f32_dpp v57, v58, v57 wave_ror:1 row_mask:0xf bank_mask:0xf
    v_add_f32_dpp v53, v54, v53 wave_ror:1 row_mask:0xf bank_mask:0xf
    v_add_f32_dpp v49, v50, v49 wave_ror:1 row_mask:0xf bank_mask:0xf
    v_add_f32_dpp v45, v46, v45 wave_ror:1 row_mask:0xf bank_mask:0xf
    v_add_f32_dpp v41, v42, v41 wave_ror:1 row_mask:0xf bank_mask:0xf
    v_add_f32_dpp v37, v38, v37 wave_ror:1 row_mask:0xf bank_mask:0xf
    v_add_f32_dpp v33, v34, v33 wave_ror:1 row_mask:0xf bank_mask:0xf
    s_mov_b32 exec_lo, 0
    s_mov_b32 exec_hi, 0x80000000
    v_mov_b32 v96, v93
    v_mov_b32 v93, v89
    v_mov_b32 v89, v85
    v_mov_b32 v85, v81
    v_mov_b32 v81, v77
    v_mov_b32 v77, v73
    v_mov_b32 v73, v69
    v_mov_b32 v69, v65
    v_mov_b32 v65, v61
    v_mov_b32 v61, v57
    v_mov_b32 v57, v53
    v_mov_b32 v53, v49
    v_mov_b32 v49, v45
    v_mov_b32 v45, v41
    v_mov_b32 v41, v37
    v_mov_b32 v37, v33
    v_mov_b32 v33, 0
    ds_write_b96 v153, v[96:98]
    v_mov_b32 v100, 1
    ds_add_u32 v155, v100
    s_mov_b64 exec, -1
    v_add_f32_dpp v92, v93, v92 wave_ror:1 row_mask:0xf bank_mask:0xf
    v_add_f32_dpp v88, v89, v88 wave_ror:1 row_mask:0xf bank_mask:0xf
    v_add_f32_dpp v84, v85, v84 wave_ror:1 row_mask:0xf bank_mask:0xf
    v_add_f32_dpp v80, v81, v80 wave_ror:1 row_mask:0xf bank_mask:0xf
    v_add_f32_dpp v76, v77, v76 wave_ror:1 row_mask:0xf bank_mask:0xf
    v_add_f32_dpp v72, v73, v72 wave_ror:1 row_mask:0xf bank_mask:0xf
    v_add_f32_dpp v68, v69, v68 wave_ror:1 row_mask:0xf bank_mask:0xf
    v_add_f32_dpp v64, v65, v64 wave_ror:1 row_mask:0xf bank_mask:0xf
    v_add_f32_dpp v60, v61, v60 wave_ror:1 row_mask:0xf bank_mask:0xf
    v_add_f32_dpp v56, v57, v56 wave_ror:1 row_mask:0xf bank_mask:0xf
    v_add_f32_dpp v52, v53, v52 wave_ror:1 row_mask:0xf bank_mask:0xf
    v_add_f32_dpp v48, v49, v48 wave_ror:1 row_mask:0xf bank_mask:0xf
    v_add_f32_dpp v44, v45, v44 wave_ror:1 row_mask:0xf bank_mask:0xf
    v_add_f32_dpp v40, v41, v40 wave_ror:1 row_mask:0xf bank_mask:0xf
    v_add_f32_dpp v36, v37, v36 wave_ror:1 row_mask:0xf bank_mask:0xf
    v_add_f32_dpp v32, v33, v32 wave_ror:1 row_mask:0xf bank_mask:0xf
    v_xor_b32 v101, 16, v153
    v_lshl_add_u32 v101, v0, 2, v101
    v_cvt_pk_bf16_f32 v105, v40, v44
    v_cvt_pk_bf16_f32 v106, v48, v52
    v_cvt_pk_bf16_f32 v107, v56, v60
    v_cvt_pk_bf16_f32 v108, v64, v68
    v_cvt_pk_bf16_f32 v109, v72, v76
    v_cvt_pk_bf16_f32 v110, v80, v84
    v_cvt_pk_bf16_f32 v111, v88, v92
    ds_write_b128 v151, v[108:111] offset:1024
    s_mov_b32 s56, 0x400000
Lls_32:
    ds_read_b32 v100, v155
    s_waitcnt lgkmcnt(0)
    v_readfirstlane_b32 s73, v100
    s_nop 0
    s_cmp_ge_u32 s73, 2
    s_cbranch_scc1 Lld_33
    s_sub_u32 s56, s56, 1
    s_cbranch_scc0 Lls_32
Lld_33:
    s_mov_b64 exec, 7
    ds_read_b32 v100, v101
    s_waitcnt lgkmcnt(0)
    v_add_f32 v32, v32, v100
    s_mov_b64 exec, -1
    v_cvt_pk_bf16_f32 v104, v32, v36
    ds_write_b128 v151, v[104:107] offset:0
    s_lshl_b32 s71, s63, 6
    s_add_u32 s70, s71, 5898240
    s_add_u32 s71, s71, 6553600
    s_lshr_b32 s72, s63, 5
    s_lshl_b32 s72, s72, 8
    s_add_u32 s72, s72, 8788992
Lconve:
    ds_read_b64_tr_b16 v[136:137], v152 offset:0
    ds_read_b64_tr_b16 v[138:139], v152 offset:64
    ds_read_b64_tr_b16 v[140:141], v152 offset:1024
    ds_read_b64_tr_b16 v[142:143], v152 offset:1088
    v_mov_b32 v152, 81920
    v_mov_b32 v153, 1
    s_waitcnt lgkmcnt(2)
    buffer_store_dwordx4 v[136:139], v154, s[44:47], s70 offen sc1
    s_waitcnt lgkmcnt(0)
    buffer_store_dwordx4 v[140:143], v154, s[44:47], s71 offen sc1
    s_mov_b32 s62, 2
    s_cmp_lt_u32 s50, 4
    s_cbranch_scc1 Ls3c
    s_waitcnt vmcnt(0)
    s_mov_b64 exec, 1
    buffer_atomic_add v153, v152, s[44:47], s72 offen sc0 sc1
    s_mov_b64 exec, -1
    s_waitcnt vmcnt(0)
    v_readfirstlane_b32 s73, v153
    s_nop 0
    s_cmp_lg_u32 s73, 31
    s_cbranch_scc1 Lal_34
    v_mov_b32 v152, 0
    v_mov_b32 v153, s55
    s_mov_b64 exec, 1
    buffer_store_dword v153, v152, s[44:47], s72 offen sc1
    s_mov_b64 exec, -1
Lal_34:
    s_mov_b32 s66, 0xffff0000
    s_branch Learly
Ls3:
    s_mov_b32 s62, 0
Ls3c:
    buffer_load_dwordx4 v[156:159], v1, s[44:47], s2 offen offset:0 sc1
    buffer_load_dwordx4 v[160:163], v1, s[44:47], s2 offen offset:1024 sc1
    buffer_load_dwordx4 v[164:167], v1, s[44:47], s2 offen offset:2048 sc1
    buffer_load_dwordx4 v[168:171], v1, s[44:47], s2 offen offset:3072 sc1
    s_add_u32 s2, s2, 4096
    buffer_load_dwordx4 v[172:175], v1, s[44:47], s2 offen offset:0 sc1
    buffer_load_dwordx4 v[176:179], v1, s[44:47], s2 offen offset:1024 sc1
    buffer_load_dwordx4 v[180:183], v1, s[44:47], s2 offen offset:2048 sc1
    buffer_load_dwordx4 v[184:187], v1, s[44:47], s2 offen offset:3072 sc1
    s_add_u32 s2, s2, 4096
    s_cmp_ge_u32 s50, 4
    s_cbranch_scc1 Lxe_35
    buffer_load_dwordx4 v[20:23], v14, s[4:7], s96 offen
    buffer_load_dwordx4 v[28:31], v14, s[4:7], s96 offen offset:32
    s_branch Lxd_36
Lxe_35:
    buffer_load_dword v20, v14, s[4:7], s96 offen
    buffer_load_dword v21, v14, s[4:7], s96 offen offset:4
Lxd_36:
    buffer_load_dword v18, v11, s[44:47], 0 offen sc1
    s_setprio 1
    v_mov_b32 v60, 0
    v_mov_b32 v61, 0
    v_mov_b32 v62, 0
    v_mov_b32 v63, 0
    v_mov_b32 v68, 0
    v_mov_b32 v69, 0
    v_mov_b32 v70, 0
    v_mov_b32 v71, 0
    v_mov_b32 v96, 0
    v_mov_b32 v97, 0
    v_mov_b32 v98, 0
    v_mov_b32 v99, 0
    v_mov_b32 v104, 0
    v_mov_b32 v105, 0
    v_mov_b32 v106, 0
    v_mov_b32 v107, 0
    v_mov_b32 v216, 0
    v_mov_b32 v217, 0
    v_mov_b32 v218, 0
    v_mov_b32 v219, 0
    v_mov_b32 v220, 0
    v_mov_b32 v221, 0
    v_mov_b32 v222, 0
    v_mov_b32 v223, 0
    v_mov_b32 v240, 0
    v_mov_b32 v241, 0
    v_mov_b32 v242, 0
    v_mov_b32 v243, 0
    v_mov_b32 v244, 0
    v_mov_b32 v245, 0
    v_mov_b32 v246, 0
    v_mov_b32 v247, 0
    s_mov_b32 s68, 0
    s_mov_b32 s56, 0x40000
    s_branch Ls3w
Ls3sl:
    s_sleep 2
    buffer_load_dword v18, v11, s[44:47], 0 offen sc1
Ls3w:
    s_waitcnt vmcnt(0)
    s_cmp_eq_u32 s62, 0
    s_cbranch_scc1 Ls3ev
    s_sub_u32 s62, s62, 1
    s_cmp_eq_u32 s62, 0
    s_cbranch_scc1 Ls3af
    s_mov_b64 exec, 1
    buffer_atomic_add v153, v152, s[44:47], s72 offen sc0 sc1
    s_mov_b64 exec, -1
    s_branch Ls3ev
Ls3af:
    s_waitcnt vmcnt(0)
    v_readfirstlane_b32 s73, v153
    s_nop 0
    s_cmp_lg_u32 s73, 31
    s_cbranch_scc1 Lal_37
    v_mov_b32 v152, 0
    v_mov_b32 v153, s55
    s_mov_b64 exec, 1
    buffer_store_dword v153, v152, s[44:47], s72 offen sc1
    s_mov_b64 exec, -1
Lal_37:
Ls3ev:
    v_cmp_ne_u32 vcc, s55, v18
    s_sub_u32 s56, s56, 1
    s_cbranch_scc1 Ls3go
    s_cmp_lg_u32 s68, 0
    s_cbranch_scc1 Ls3k
    s_and_b32 s66, vcc_lo, 3
    s_cbranch_scc1 Ls3sl
    s_add_u32 s70, s97, 0
    s_add_u32 s67, s70, 4096
    buffer_load_dwordx4 v[32:35], v1, s[44:47], s70 offen offset:0 sc1
    buffer_load_dwordx4 v[36:39], v1, s[44:47], s70 offen offset:1024 sc1
    buffer_load_dwordx4 v[40:43], v1, s[44:47], s70 offen offset:2048 sc1
    buffer_load_dwordx4 v[44:47], v1, s[44:47], s70 offen offset:3072 sc1
    buffer_load_dwordx4 v[48:51], v1, s[44:47], s67 offen sc1
    s_add_u32 s70, s97, 20480
    s_add_u32 s67, s70, 4096
    buffer_load_dwordx4 v[188:191], v1, s[44:47], s70 offen offset:0 sc1
    buffer_load_dwordx4 v[192:195], v1, s[44:47], s70 offen offset:1024 sc1
    buffer_load_dwordx4 v[196:199], v1, s[44:47], s70 offen offset:2048 sc1
    buffer_load_dwordx4 v[200:203], v1, s[44:47], s70 offen offset:3072 sc1
    buffer_load_dwordx4 v[204:207], v1, s[44:47], s67 offen sc1
    s_mov_b32 s68, 1
    v_mov_b32 v11, v27
Ls3k:
    s_bitcmp1_b32 vcc_lo, 2
    s_cbranch_scc1 Ls3sl
Ls3go:
    s_mov_b32 s65, vcc_hi
    s_add_u32 s70, s98, 0
    s_add_u32 s69, s70, 3584
    buffer_load_dwordx4 v[52:55], v9, s[44:47], s70 offen offset:0 sc1
    buffer_load_dwordx4 v[56:59], v9, s[44:47], s70 offen offset:672 sc1
    s_mov_b32 exec_hi, 0
    buffer_load_dwordx4 v[60:63], v9, s[44:47], s70 offen offset:1344 sc1
    s_mov_b64 exec, -1
    s_mov_b32 exec_lo, 0
    buffer_load_dwordx4 v[68:71], v10, s[44:47], s70 offen offset:1456 sc1
    s_mov_b64 exec, -1
    buffer_load_dwordx4 v[72:75], v10, s[44:47], s70 offen offset:2128 sc1
    buffer_load_dwordx4 v[76:79], v10, s[44:47], s70 offen offset:2800 sc1
    buffer_load_dwordx4 v[88:91], v9, s[44:47], s69 offen offset:0 sc1
    buffer_load_dwordx4 v[92:95], v9, s[44:47], s69 offen offset:672 sc1
    s_mov_b32 exec_hi, 0
    buffer_load_dwordx4 v[96:99], v9, s[44:47], s69 offen offset:1344 sc1
    s_mov_b64 exec, -1
    s_mov_b32 exec_lo, 0
    buffer_load_dwordx4 v[104:107], v10, s[44:47], s69 offen offset:1456 sc1
    s_mov_b64 exec, -1
    buffer_load_dwordx4 v[108:111], v10, s[44:47], s69 offen offset:2128 sc1
    buffer_load_dwordx4 v[112:115], v10, s[44:47], s69 offen offset:2800 sc1
    s_cmp_eq_u32 s62, 0
    s_cbranch_scc1 Ls3n4
    s_waitcnt vmcnt(12)
    v_readfirstlane_b32 s73, v153
    s_nop 0
    s_cmp_lg_u32 s73, 31
    s_cbranch_scc1 Lal_38
    v_mov_b32 v152, 0
    v_mov_b32 v153, s55
    s_mov_b64 exec, 1
    buffer_store_dword v153, v152, s[44:47], s72 offen sc1
    s_mov_b64 exec, -1
Lal_38:
Ls3n4:
    s_cmp_eq_u32 s65, 0
    s_cbranch_scc1 Ls3k2
    buffer_load_dword v18, v11, s[44:47], 0 offen sc1
    s_waitcnt vmcnt(0)
    v_cmp_ne_u32 vcc, s55, v18
    s_nop 0
    s_mov_b32 s65, vcc_hi
    s_cmp_lg_u32 s65, 0
    s_cbranch_scc1 Ls3p1
Ls3k2:
    s_add_u32 s70, s98, 28672
    s_add_u32 s69, s70, 3584
    buffer_load_dwordx4 v[208:211], v9, s[44:47], s70 offen offset:0 sc1
    buffer_load_dwordx4 v[212:215], v9, s[44:47], s70 offen offset:672 sc1
    s_mov_b32 exec_hi, 0
    buffer_load_dwordx4 v[216:219], v9, s[44:47], s70 offen offset:1344 sc1
    s_mov_b64 exec, -1
    s_mov_b32 exec_lo, 0
    buffer_load_dwordx4 v[220:223], v10, s[44:47], s70 offen offset:1456 sc1
    s_mov_b64 exec, -1
    buffer_load_dwordx4 v[224:227], v10, s[44:47], s70 offen offset:2128 sc1
    buffer_load_dwordx4 v[228:231], v10, s[44:47], s70 offen offset:2800 sc1
    buffer_load_dwordx4 v[232:235], v9, s[44:47], s69 offen offset:0 sc1
    buffer_load_dwordx4 v[236:239], v9, s[44:47], s69 offen offset:672 sc1
    s_mov_b32 exec_hi, 0
    buffer_load_dwordx4 v[240:243], v9, s[44:47], s69 offen offset:1344 sc1
    s_mov_b64 exec, -1
    s_mov_b32 exec_lo, 0
    buffer_load_dwordx4 v[244:247], v10, s[44:47], s69 offen offset:1456 sc1
    s_mov_b64 exec, -1
    buffer_load_dwordx4 v[248:251], v10, s[44:47], s69 offen offset:2128 sc1
    buffer_load_dwordx4 v[252:255], v10, s[44:47], s69 offen offset:2800 sc1
Ls3p1:
    s_waitcnt vmcnt(21)
    v_cvt_pk_bf16_f32 v116, v52, v53
    v_cvt_pk_bf16_f32 v117, v54, v55
    v_cvt_pk_bf16_f32 v118, v56, v57
    v_cvt_pk_bf16_f32 v119, v58, v59
    v_cvt_pk_bf16_f32 v120, v60, v61
    v_cvt_pk_bf16_f32 v121, v62, v63
    v_mov_b32 v122, 0
    v_mov_b32 v123, 0
    v_mfma_f32_32x32x16_bf16 v[52:67], v[116:119], v[32:35], 0
    s_nop 0
    v_mfma_f32_32x32x16_bf16 v[52:67], v[120:123], v[36:39], v[52:67]
    s_waitcnt vmcnt(18)
    v_cvt_pk_bf16_f32 v124, v68, v69
    v_cvt_pk_bf16_f32 v125, v70, v71
    v_cvt_pk_bf16_f32 v126, v72, v73
    v_cvt_pk_bf16_f32 v127, v74, v75
    v_cvt_pk_bf16_f32 v128, v76, v77
    v_cvt_pk_bf16_f32 v129, v78, v79
    v_mov_b32 v130, 0
    v_mov_b32 v131, 0
    v_mfma_f32_32x32x16_bf16 v[68:83], v[124:127], v[36:39], 0
    s_nop 0
    v_mfma_f32_32x32x16_bf16 v[68:83], v[128:131], v[40:43], v[68:83]
    s_waitcnt vmcnt(15)
    v_mov_b32 v116, 0
    v_mov_b32 v117, 0
    v_cvt_pk_bf16_f32 v118, v88, v89
    v_cvt_pk_bf16_f32 v119, v90, v91
    v_cvt_pk_bf16_f32 v120, v92, v93
    v_cvt_pk_bf16_f32 v121, v94, v95
    v_cvt_pk_bf16_f32 v122, v96, v97
    v_cvt_pk_bf16_f32 v123, v98, v99
    v_mfma_f32_32x32x16_bf16 v[84:99], v[116:119], v[40:43], 0
    s_nop 0
    v_mfma_f32_32x32x16_bf16 v[84:99], v[120:123], v[44:47], v[84:99]
    s_waitcnt vmcnt(12)
    v_mov_b32 v124, 0
    v_mov_b32 v125, 0
    v_cvt_pk_bf16_f32 v126, v104, v105
    v_cvt_pk_bf16_f32 v127, v106, v107
    v_cvt_pk_bf16_f32 v128, v108, v109
    v_cvt_pk_bf16_f32 v129, v110, v111
    v_cvt_pk_bf16_f32 v130, v112, v113
    v_cvt_pk_bf16_f32 v131, v114, v115
    v_mfma_f32_32x32x16_bf16 v[100:115], v[124:127], v[44:47], 0
    s_nop 0
    v_mfma_f32_32x32x16_bf16 v[100:115], v[128:131], v[48:51], v[100:115]
    v_add_f32 v64, s79, v64
    v_rcp_f32 v64, v64
    s_nop 0
    v_mul_f32 v52, v52, v64
    v_mul_f32 v53, v53, v64
    v_mul_f32 v54, v54, v64
    v_mul_f32 v55, v55, v64
    v_mul_f32 v56, v56, v64
    v_mul_f32 v57, v57, v64
    v_mul_f32 v58, v58, v64
    v_mul_f32 v59, v59, v64
    v_cvt_pk_bf16_f32 v132, v52, v53
    v_cvt_pk_bf16_f32 v133, v54, v55
    v_cvt_pk_bf16_f32 v134, v56, v57
    v_cvt_pk_bf16_f32 v135, v58, v59
    ds_write_b128 v2, v[132:135] offset:0
    v_mul_f32 v60, v60, v64
    v_mul_f32 v61, v61, v64
    v_mul_f32 v62, v62, v64
    v_mul_f32 v63, v63, v64
    v_add_f32 v80, s79, v80
    v_rcp_f32 v80, v80
    s_nop 0
    v_mul_f32 v68, v68, v80
    v_mul_f32 v69, v69, v80
    v_mul_f32 v70, v70, v80
    v_mul_f32 v71, v71, v80
    v_mul_f32 v72, v72, v80
    v_mul_f32 v73, v73, v80
    v_mul_f32 v74, v74, v80
    v_mul_f32 v75, v75, v80
    v_cvt_pk_bf16_f32 v136, v68, v69
    v_cvt_pk_bf16_f32 v137, v70, v71
    v_cvt_pk_bf16_f32 v138, v72, v73
    v_cvt_pk_bf16_f32 v139, v74, v75
    ds_write_b128 v2, v[136:139] offset:1024
    v_fmac_f32 v60, v76, v80
    v_fmac_f32 v61, v77, v80
    v_fmac_f32 v62, v78, v80
    v_fmac_f32 v63, v79, v80
    v_cvt_pk_bf16_f32 v148, v60, v61
    v_cvt_pk_bf16_f32 v149, v62, v63
    v_add_f32 v96, s79, v96
    v_rcp_f32 v96, v96
    s_nop 0
    v_mul_f32 v84, v84, v96
    v_mul_f32 v85, v85, v96
    v_mul_f32 v86, v86, v96
    v_mul_f32 v87, v87, v96
    v_mul_f32 v88, v88, v96
    v_mul_f32 v89, v89, v96
    v_mul_f32 v90, v90, v96
    v_mul_f32 v91, v91, v96
    v_cvt_pk_bf16_f32 v140, v84, v85
    v_cvt_pk_bf16_f32 v141, v86, v87
    v_cvt_pk_bf16_f32 v142, v88, v89
    v_cvt_pk_bf16_f32 v143, v90, v91
    ds_write_b128 v2, v[140:143] offset:2048
    v_mul_f32 v92, v92, v96
    v_mul_f32 v93, v93, v96
    v_mul_f32 v94, v94, v96
    v_mul_f32 v95, v95, v96
    v_add_f32 v112, s79, v112
    v_rcp_f32 v112, v112
    s_nop 0
    v_mul_f32 v100, v100, v112
    v_mul_f32 v101, v101, v112
    v_mul_f32 v102, v102, v112
    v_mul_f32 v103, v103, v112
    v_mul_f32 v104, v104, v112
    v_mul_f32 v105, v105, v112
    v_mul_f32 v106, v106, v112
    v_mul_f32 v107, v107, v112
    v_cvt_pk_bf16_f32 v144, v100, v101
    v_cvt_pk_bf16_f32 v145, v102, v103
    v_cvt_pk_bf16_f32 v146, v104, v105
    v_cvt_pk_bf16_f32 v147, v106, v107
    ds_write_b128 v2, v[144:147] offset:3072
    v_fmac_f32 v92, v108, v112
    v_fmac_f32 v93, v109, v112
    v_fmac_f32 v94, v110, v112
    v_fmac_f32 v95, v111, v112
    v_cvt_pk_bf16_f32 v150, v92, v93
    v_cvt_pk_bf16_f32 v151, v94, v95
    ds_write_b128 v2, v[148:151] offset:4096
    s_cmp_eq_u32 s65, 0
    s_cbranch_scc1 Ls3p2
    s_mov_b32 s56, 0x20000
Lpoll_39:
    buffer_load_dword v18, v11, s[44:47], 0 offen sc1
    s_waitcnt vmcnt(0)
    v_cmp_ne_u32 vcc, s55, v18
    s_cbranch_vccz Lpd_40
    s_sleep 2
    s_sub_u32 s56, s56, 1
    s_cbranch_scc0 Lpoll_39
Lpd_40:
    s_add_u32 s70, s98, 28672
    s_add_u32 s69, s70, 3584
    buffer_load_dwordx4 v[208:211], v9, s[44:47], s70 offen offset:0 sc1
    buffer_load_dwordx4 v[212:215], v9, s[44:47], s70 offen offset:672 sc1
    s_mov_b32 exec_hi, 0
    buffer_load_dwordx4 v[216:219], v9, s[44:47], s70 offen offset:1344 sc1
    s_mov_b64 exec, -1
    s_mov_b32 exec_lo, 0
    buffer_load_dwordx4 v[220:223], v10, s[44:47], s70 offen offset:1456 sc1
    s_mov_b64 exec, -1
    buffer_load_dwordx4 v[224:227], v10, s[44:47], s70 offen offset:2128 sc1
    buffer_load_dwordx4 v[228:231], v10, s[44:47], s70 offen offset:2800 sc1
    buffer_load_dwordx4 v[232:235], v9, s[44:47], s69 offen offset:0 sc1
    buffer_load_dwordx4 v[236:239], v9, s[44:47], s69 offen offset:672 sc1
    s_mov_b32 exec_hi, 0
    buffer_load_dwordx4 v[240:243], v9, s[44:47], s69 offen offset:1344 sc1
    s_mov_b64 exec, -1
    s_mov_b32 exec_lo, 0
    buffer_load_dwordx4 v[244:247], v10, s[44:47], s69 offen offset:1456 sc1
    s_mov_b64 exec, -1
    buffer_load_dwordx4 v[248:251], v10, s[44:47], s69 offen offset:2128 sc1
    buffer_load_dwordx4 v[252:255], v10, s[44:47], s69 offen offset:2800 sc1
Ls3p2:
    s_waitcnt vmcnt(9)
    v_cvt_pk_bf16_f32 v116, v208, v209
    v_cvt_pk_bf16_f32 v117, v210, v211
    v_cvt_pk_bf16_f32 v118, v212, v213
    v_cvt_pk_bf16_f32 v119, v214, v215
    v_cvt_pk_bf16_f32 v120, v216, v217
    v_cvt_pk_bf16_f32 v121, v218, v219
    v_mov_b32 v122, 0
    v_mov_b32 v123, 0
    v_mfma_f32_32x32x16_bf16 v[52:67], v[116:119], v[188:191], 0
    s_nop 0
    v_mfma_f32_32x32x16_bf16 v[52:67], v[120:123], v[192:195], v[52:67]
    s_waitcnt vmcnt(6)
    v_cvt_pk_bf16_f32 v124, v220, v221
    v_cvt_pk_bf16_f32 v125, v222, v223
    v_cvt_pk_bf16_f32 v126, v224, v225
    v_cvt_pk_bf16_f32 v127, v226, v227
    v_cvt_pk_bf16_f32 v128, v228, v229
    v_cvt_pk_bf16_f32 v129, v230, v231
    v_mov_b32 v130, 0
    v_mov_b32 v131, 0
    v_mfma_f32_32x32x16_bf16 v[68:83], v[124:127], v[192:195], 0
    s_nop 0
    v_mfma_f32_32x32x16_bf16 v[68:83], v[128:131], v[196:199], v[68:83]
    s_waitcnt vmcnt(3)
    v_mov_b32 v116, 0
    v_mov_b32 v117, 0
    v_cvt_pk_bf16_f32 v118, v232, v233
    v_cvt_pk_bf16_f32 v119, v234, v235
    v_cvt_pk_bf16_f32 v120, v236, v237
    v_cvt_pk_bf16_f32 v121, v238, v239
    v_cvt_pk_bf16_f32 v122, v240, v241
    v_cvt_pk_bf16_f32 v123, v242, v243
    v_mfma_f32_32x32x16_bf16 v[84:99], v[116:119], v[196:199], 0
    s_nop 0
    v_mfma_f32_32x32x16_bf16 v[84:99], v[120:123], v[200:203], v[84:99]
    s_waitcnt vmcnt(0)
    v_mov_b32 v124, 0
    v_mov_b32 v125, 0
    v_cvt_pk_bf16_f32 v126, v244, v245
    v_cvt_pk_bf16_f32 v127, v246, v247
    v_cvt_pk_bf16_f32 v128, v248, v249
    v_cvt_pk_bf16_f32 v129, v250, v251
    v_cvt_pk_bf16_f32 v130, v252, v253
    v_cvt_pk_bf16_f32 v131, v254, v255
    v_mfma_f32_32x32x16_bf16 v[100:115], v[124:127], v[200:203], 0
    s_nop 0
    v_mfma_f32_32x32x16_bf16 v[100:115], v[128:131], v[204:207], v[100:115]
    v_mov_b32 v152, 146060
    v_mov_b32 v153, 1
    s_mov_b64 exec, 1
    ds_add_u32 v152, v153
    s_mov_b64 exec, -1
    v_add_f32 v64, s79, v64
    v_rcp_f32 v64, v64
    s_nop 0
    v_mul_f32 v52, v52, v64
    v_mul_f32 v53, v53, v64
    v_mul_f32 v54, v54, v64
    v_mul_f32 v55, v55, v64
    v_mul_f32 v56, v56, v64
    v_mul_f32 v57, v57, v64
    v_mul_f32 v58, v58, v64
    v_mul_f32 v59, v59, v64
    v_cvt_pk_bf16_f32 v132, v52, v53
    v_cvt_pk_bf16_f32 v133, v54, v55
    v_cvt_pk_bf16_f32 v134, v56, v57
    v_cvt_pk_bf16_f32 v135, v58, v59
    ds_write_b128 v2, v[132:135] offset:20480
    v_mul_f32 v60, v60, v64
    v_mul_f32 v61, v61, v64
    v_mul_f32 v62, v62, v64
    v_mul_f32 v63, v63, v64
    v_add_f32 v80, s79, v80
    v_rcp_f32 v80, v80
    s_nop 0
    v_mul_f32 v68, v68, v80
    v_mul_f32 v69, v69, v80
    v_mul_f32 v70, v70, v80
    v_mul_f32 v71, v71, v80
    v_mul_f32 v72, v72, v80
    v_mul_f32 v73, v73, v80
    v_mul_f32 v74, v74, v80
    v_mul_f32 v75, v75, v80
    v_cvt_pk_bf16_f32 v136, v68, v69
    v_cvt_pk_bf16_f32 v137, v70, v71
    v_cvt_pk_bf16_f32 v138, v72, v73
    v_cvt_pk_bf16_f32 v139, v74, v75
    ds_write_b128 v2, v[136:139] offset:21504
    v_fmac_f32 v60, v76, v80
    v_fmac_f32 v61, v77, v80
    v_fmac_f32 v62, v78, v80
    v_fmac_f32 v63, v79, v80
    v_cvt_pk_bf16_f32 v148, v60, v61
    v_cvt_pk_bf16_f32 v149, v62, v63
    v_add_f32 v96, s79, v96
    v_rcp_f32 v96, v96
    s_nop 0
    v_mul_f32 v84, v84, v96
    v_mul_f32 v85, v85, v96
    v_mul_f32 v86, v86, v96
    v_mul_f32 v87, v87, v96
    v_mul_f32 v88, v88, v96
    v_mul_f32 v89, v89, v96
    v_mul_f32 v90, v90, v96
    v_mul_f32 v91, v91, v96
    v_cvt_pk_bf16_f32 v140, v84, v85
    v_cvt_pk_bf16_f32 v141, v86, v87
    v_cvt_pk_bf16_f32 v142, v88, v89
    v_cvt_pk_bf16_f32 v143, v90, v91
    ds_write_b128 v2, v[140:143] offset:22528
    v_mul_f32 v92, v92, v96
    v_mul_f32 v93, v93, v96
    v_mul_f32 v94, v94, v96
    v_mul_f32 v95, v95, v96
    v_add_f32 v112, s79, v112
    v_rcp_f32 v112, v112
    s_nop 0
    v_mul_f32 v100, v100, v112
    v_mul_f32 v101, v101, v112
    v_mul_f32 v102, v102, v112
    v_mul_f32 v103, v103, v112
    v_mul_f32 v104, v104, v112
    v_mul_f32 v105, v105, v112
    v_mul_f32 v106, v106, v112
    v_mul_f32 v107, v107, v112
    v_cvt_pk_bf16_f32 v144, v100, v101
    v_cvt_pk_bf16_f32 v145, v102, v103
    v_cvt_pk_bf16_f32 v146, v104, v105
    v_cvt_pk_bf16_f32 v147, v106, v107
    ds_write_b128 v2, v[144:147] offset:23552
    v_fmac_f32 v92, v108, v112
    v_fmac_f32 v93, v109, v112
    v_fmac_f32 v94, v110, v112
    v_fmac_f32 v95, v111, v112
    v_cvt_pk_bf16_f32 v150, v92, v93
    v_cvt_pk_bf16_f32 v151, v94, v95
    ds_write_b128 v2, v[148:151] offset:24576
    s_mov_b32 s66, 0xffff0000
    s_branch Llate
Learly:
    s_setprio 2
    s_mov_b32 s65, 0
    v_mov_b32 v152, 146060
    s_mov_b32 s56, 0x40000
Ls3yl:
    buffer_load_dword v18, v12, s[44:47], 0 offen sc1
    s_waitcnt vmcnt(0)
    v_cmp_ne_u32 vcc, s55, v18
    s_cbranch_vccz Ls3yk
    s_sleep 2
    ds_read_b32 v153, v152
    s_waitcnt lgkmcnt(0)
    v_readfirstlane_b32 s73, v153
    s_nop 0
    s_cmp_ge_u32 s73, 3
    s_cbranch_scc1 Ls3y0
    s_sub_u32 s56, s56, 1
    s_cbranch_scc0 Ls3yl
    s_branch Ls3y0
Ls3yk:
    s_add_u32 m0, s101, 146176
    s_add_u32 s67, s100, s101
    buffer_load_dwordx4 v1, s[44:47], s67 offen sc1 lds
    buffer_load_dwordx4 v1, s[44:47], s67 offen offset:1024 sc1 lds
    s_lshr_b32 s68, s101, 2
    s_add_u32 s68, s68, 8192
    s_add_u32 m0, s68, 146176
    s_add_u32 s67, s100, s68
    s_mov_b32 exec_hi, 0
    buffer_load_dwordx4 v1, s[44:47], s67 offen sc1 lds
    s_mov_b32 exec_hi, -1
    s_mov_b32 s65, 1
Ls3y0:
    s_waitcnt lgkmcnt(0)
    s_barrier
    buffer_load_dword v24, v19, s[44:47], 0 offen sc1
    ds_read_b128 v[32:35], v3 offset:25600
    ds_read_b128 v[36:39], v3 offset:26624
    ds_read_b128 v[40:43], v3 offset:27648
    ds_read_b128 v[44:47], v3 offset:28672
    ds_read_b128 v[48:51], v3 offset:29696
    ds_read_b128 v[52:55], v3 offset:30720
    ds_read_b128 v[56:59], v3 offset:31744
    ds_read_b128 v[60:63], v3 offset:32768
    s_waitcnt lgkmcnt(7)
    v_mfma_f32_32x32x16_bf16 v[64:79], v[156:159], v[32:35], 0
    ds_read_b128 v[32:35], v3 offset:33792
    s_waitcnt lgkmcnt(7)
    v_mfma_f32_32x32x16_bf16 v[64:79], v[160:163], v[36:39], v[64:79]
    ds_read_b128 v[36:39], v3 offset:34816
    s_waitcnt lgkmcnt(7)
    v_mfma_f32_32x32x16_bf16 v[64:79], v[164:167], v[40:43], v[64:79]
    ds_read_b128 v[40:43], v3 offset:35840
    s_waitcnt lgkmcnt(7)
    v_mfma_f32_32x32x16_bf16 v[64:79], v[168:171], v[44:47], v[64:79]
    ds_read_b128 v[44:47], v3 offset:36864
    s_waitcnt lgkmcnt(7)
    v_mfma_f32_32x32x16_bf16 v[64:79], v[172:175], v[48:51], v[64:79]
    ds_read_b128 v[48:51], v3 offset:37888
    s_waitcnt lgkmcnt(7)
    v_mfma_f32_32x32x16_bf16 v[64:79], v[176:179], v[52:55], v[64:79]
    ds_read_b128 v[52:55], v3 offset:38912
    s_waitcnt lgkmcnt(7)
    v_mfma_f32_32x32x16_bf16 v[64:79], v[180:183], v[56:59], v[64:79]
    ds_read_b128 v[56:59], v3 offset:39936
    s_waitcnt lgkmcnt(7)
    v_mfma_f32_32x32x16_bf16 v[64:79], v[184:187], v[60:63], v[64:79]
    ds_read_b128 v[60:63], v4 offset:0
    s_waitcnt lgkmcnt(7)
    v_mfma_f32_32x32x16_bf16 v[64:79], v[188:191], v[32:35], v[64:79]
    ds_read_b128 v[32:35], v4 offset:1024
    s_waitcnt lgkmcnt(7)
    v_mfma_f32_32x32x16_bf16 v[64:79], v[192:195], v[36:39], v[64:79]
    ds_read_b128 v[36:39], v4 offset:2048
    s_waitcnt lgkmcnt(7)
    v_mfma_f32_32x32x16_bf16 v[64:79], v[196:199], v[40:43], v[64:79]
    ds_read_b128 v[40:43], v4 offset:3072
    s_waitcnt lgkmcnt(7)
    v_mfma_f32_32x32x16_bf16 v[64:79], v[200:203], v[44:47], v[64:79]
    ds_read_b128 v[44:47], v4 offset:4096
    s_waitcnt lgkmcnt(7)
    v_mfma_f32_32x32x16_bf16 v[64:79], v[204:207], v[48:51], v[64:79]
    ds_read_b128 v[48:51], v4 offset:5120
    buffer_load_dword v18, v12, s[44:47], 0 offen sc1
    s_waitcnt lgkmcnt(7)
    v_mfma_f32_32x32x16_bf16 v[64:79], v[208:211], v[52:55], v[64:79]
    ds_read_b128 v[52:55], v4 offset:6144
    s_waitcnt lgkmcnt(7)
    v_mfma_f32_32x32x16_bf16 v[64:79], v[212:215], v[56:59], v[64:79]
    ds_read_b128 v[56:59], v4 offset:7168
    s_waitcnt lgkmcnt(7)
    v_mfma_f32_32x32x16_bf16 v[80:95], v[216:219], v[60:63], 0
    ds_read_b128 v[60:63], v4 offset:8192
    s_waitcnt lgkmcnt(7)
    v_mfma_f32_32x32x16_bf16 v[80:95], v[220:223], v[32:35], v[80:95]
    ds_read_b128 v[32:35], v4 offset:9216
    s_waitcnt lgkmcnt(7)
    v_mfma_f32_32x32x16_bf16 v[80:95], v[224:227], v[36:39], v[80:95]
    s_waitcnt lgkmcnt(6)
    v_mfma_f32_32x32x16_bf16 v[80:95], v[228:231], v[40:43], v[80:95]
    s_waitcnt lgkmcnt(5)
    v_mfma_f32_32x32x16_bf16 v[80:95], v[232:235], v[44:47], v[80:95]
    ds_write_b128 v5, v[64:67] offset:0
    s_waitcnt lgkmcnt(5)
    v_mfma_f32_32x32x16_bf16 v[80:95], v[236:239], v[48:51], v[80:95]
    ds_write_b128 v5, v[68:71] offset:1024
    s_waitcnt lgkmcnt(5)
    v_mfma_f32_32x32x16_bf16 v[80:95], v[240:243], v[52:55], v[80:95]
    ds_write_b128 v5, v[72:75] offset:2048
    s_waitcnt lgkmcnt(5)
    v_mfma_f32_32x32x16_bf16 v[80:95], v[244:247], v[56:59], v[80:95]
    ds_write_b128 v5, v[76:79] offset:3072
    s_waitcnt lgkmcnt(5)
    v_mfma_f32_32x32x16_bf16 v[80:95], v[248:251], v[60:63], v[80:95]
    s_waitcnt lgkmcnt(4)
    v_mfma_f32_32x32x16_bf16 v[80:95], v[252:255], v[32:35], v[80:95]
    s_cmp_eq_u32 s65, 1
    s_nop 7
    s_nop 1
    s_cbranch_scc1 Ls3yd
    s_waitcnt vmcnt(0)
    v_cmp_ne_u32 vcc, s55, v18
    s_cbranch_vccz Lpd_42
    s_mov_b32 s56, 0x20000
Lpoll_41:
    buffer_load_dword v18, v12, s[44:47], 0 offen sc1
    s_waitcnt vmcnt(0)
    v_cmp_ne_u32 vcc, s55, v18
    s_cbranch_vccz Lpd_42
    s_sleep 1
    s_sub_u32 s56, s56, 1
    s_cbranch_scc0 Lpoll_41
Lpd_42:
    s_add_u32 m0, s101, 146176
    s_add_u32 s67, s100, s101
    buffer_load_dwordx4 v1, s[44:47], s67 offen sc1 lds
    buffer_load_dwordx4 v1, s[44:47], s67 offen offset:1024 sc1 lds
    s_lshr_b32 s68, s101, 2
    s_add_u32 s68, s68, 8192
    s_add_u32 m0, s68, 146176
    s_add_u32 s67, s100, s68
    s_mov_b32 exec_hi, 0
    buffer_load_dwordx4 v1, s[44:47], s67 offen sc1 lds
    s_mov_b32 exec_hi, -1
Ls3yd:
    ds_write_b128 v5, v[80:83] offset:16384
    ds_write_b128 v5, v[84:87] offset:17408
    ds_write_b128 v5, v[88:91] offset:18432
    ds_write_b128 v5, v[92:95] offset:19456
    v_lshlrev_b32 v96, 16, v20
    v_and_b32 v97, s66, v20
    v_lshlrev_b32 v98, 16, v21
    v_and_b32 v99, s66, v21
    s_waitcnt vmcnt(0) lgkmcnt(0)
    s_barrier
    ds_read_b128 v[32:35], v15 offset:0
    ds_read_b128 v[36:39], v15 offset:4096
    ds_read_b128 v[40:43], v15 offset:8192
    ds_read_b128 v[44:47], v15 offset:12288
    ds_read_b64_tr_b16 v[112:113], v17
    s_waitcnt lgkmcnt(1)
    v_pk_add_f32 v[32:33], v[32:33], v[36:37]
    v_pk_add_f32 v[34:35], v[34:35], v[38:39]
    v_pk_add_f32 v[40:41], v[40:41], v[44:45]
    v_pk_add_f32 v[42:43], v[42:43], v[46:47]
    v_pk_add_f32 v[32:33], v[32:33], v[40:41]
    v_pk_add_f32 v[34:35], v[34:35], v[42:43]
    s_waitcnt lgkmcnt(0)
    v_lshlrev_b32 v120, 16, v112
    v_and_b32 v121, s66, v112
    v_lshlrev_b32 v122, 16, v113
    v_and_b32 v123, s66, v113
    v_pk_mul_f32 v[96:97], v[96:97], v[120:121]
    v_pk_mul_f32 v[98:99], v[98:99], v[122:123]
    v_pk_add_f32 v[32:33], v[32:33], v[96:97] neg_lo:[0,1] neg_hi:[0,1]
    v_pk_add_f32 v[34:35], v[34:35], v[98:99] neg_lo:[0,1] neg_hi:[0,1]
    v_pk_fma_f32 v[32:33], v[32:33], v[24:25], v[96:97] op_sel_hi:[1,0,1]
    v_pk_fma_f32 v[34:35], v[34:35], v[24:25], v[98:99] op_sel_hi:[1,0,1]
    v_cvt_pk_bf16_f32 v112, v32, v33
    v_cvt_pk_bf16_f32 v113, v34, v35
    buffer_store_dwordx2 v[112:113], v14, s[36:39], s96 offen
    s_branch Lfin
Llate:
    s_setprio 1
    s_waitcnt lgkmcnt(0)
    s_barrier
    buffer_load_dword v24, v19, s[44:47], 0 offen sc1
    ds_read_b128 v[32:35], v3 offset:0
    ds_read_b128 v[36:39], v3 offset:1024
    ds_read_b128 v[40:43], v3 offset:2048
    ds_read_b128 v[44:47], v3 offset:3072
    ds_read_b128 v[48:51], v3 offset:4096
    ds_read_b128 v[52:55], v3 offset:5120
    ds_read_b128 v[56:59], v3 offset:6144
    ds_read_b128 v[60:63], v3 offset:7168
    buffer_load_dwordx4 v[188:191], v1, s[44:47], s2 offen offset:0 sc1
    buffer_load_dwordx4 v[192:195], v1, s[44:47], s2 offen offset:1024 sc1
    buffer_load_dwordx4 v[196:199], v1, s[44:47], s2 offen offset:2048 sc1
    buffer_load_dwordx4 v[200:203], v1, s[44:47], s2 offen offset:3072 sc1
    s_add_u32 s2, s2, 4096
    buffer_load_dwordx4 v[204:207], v1, s[44:47], s2 offen offset:0 sc1
    buffer_load_dwordx4 v[208:211], v1, s[44:47], s2 offen offset:1024 sc1
    buffer_load_dwordx4 v[212:215], v1, s[44:47], s2 offen offset:2048 sc1
    buffer_load_dwordx4 v[216:219], v1, s[44:47], s2 offen offset:3072 sc1
    s_add_u32 s2, s2, 4096
    buffer_load_dwordx4 v[220:223], v1, s[44:47], s2 offen offset:0 sc1
    buffer_load_dwordx4 v[224:227], v1, s[44:47], s2 offen offset:1024 sc1
    buffer_load_dwordx4 v[228:231], v1, s[44:47], s2 offen offset:2048 sc1
    buffer_load_dwordx4 v[232:235], v1, s[44:47], s2 offen offset:3072 sc1
    s_add_u32 s2, s2, 4096
    buffer_load_dwordx4 v[236:239], v1, s[44:47], s2 offen offset:0 sc1
    buffer_load_dwordx4 v[240:243], v1, s[44:47], s2 offen offset:1024 sc1
    buffer_load_dwordx4 v[244:247], v1, s[44:47], s2 offen offset:2048 sc1
    buffer_load_dwordx4 v[248:251], v1, s[44:47], s2 offen offset:3072 sc1
    s_add_u32 s2, s2, 4096
    buffer_load_dwordx4 v[252:255], v1, s[44:47], s2 offen offset:0 sc1
    s_waitcnt lgkmcnt(7)
    v_mfma_f32_32x32x16_bf16 v[64:79], v[156:159], v[32:35], 0
    ds_read_b128 v[32:35], v3 offset:8192
    v_permlane32_swap_b32 v20, v22
    v_permlane32_swap_b32 v21, v23
    s_waitcnt lgkmcnt(7)
    v_mfma_f32_32x32x16_bf16 v[64:79], v[160:163], v[36:39], v[64:79]
    ds_read_b128 v[36:39], v3 offset:9216
    v_permlane32_swap_b32 v28, v30
    v_permlane32_swap_b32 v29, v31
    s_waitcnt lgkmcnt(7)
    v_mfma_f32_32x32x16_bf16 v[64:79], v[164:167], v[40:43], v[64:79]
    ds_read_b128 v[40:43], v3 offset:10240
    v_lshlrev_b32 v96, 16, v20
    v_and_b32 v97, s66, v20
    s_waitcnt lgkmcnt(7)
    v_mfma_f32_32x32x16_bf16 v[64:79], v[168:171], v[44:47], v[64:79]
    ds_read_b128 v[44:47], v3 offset:11264
    v_lshlrev_b32 v98, 16, v21
    v_and_b32 v99, s66, v21
    s_waitcnt lgkmcnt(7)
    v_mfma_f32_32x32x16_bf16 v[64:79], v[172:175], v[48:51], v[64:79]
    ds_read_b128 v[48:51], v3 offset:12288
    v_lshlrev_b32 v100, 16, v22
    v_and_b32 v101, s66, v22
    s_waitcnt lgkmcnt(7)
    v_mfma_f32_32x32x16_bf16 v[64:79], v[176:179], v[52:55], v[64:79]
    ds_read_b128 v[52:55], v3 offset:13312
    v_lshlrev_b32 v102, 16, v23
    v_and_b32 v103, s66, v23
    s_waitcnt lgkmcnt(7)
    v_mfma_f32_32x32x16_bf16 v[64:79], v[180:183], v[56:59], v[64:79]
    ds_read_b128 v[56:59], v3 offset:14336
    v_lshlrev_b32 v104, 16, v28
    v_and_b32 v105, s66, v28
    s_waitcnt lgkmcnt(7)
    v_mfma_f32_32x32x16_bf16 v[64:79], v[184:187], v[60:63], v[64:79]
    ds_read_b128 v[60:63], v3 offset:15360
    v_lshlrev_b32 v106, 16, v29
    v_and_b32 v107, s66, v29
    s_waitcnt vmcnt(16) lgkmcnt(7)
    v_mfma_f32_32x32x16_bf16 v[64:79], v[188:191], v[32:35], v[64:79]
    ds_read_b128 v[32:35], v3 offset:16384
    v_lshlrev_b32 v108, 16, v30
    v_and_b32 v109, s66, v30
    s_waitcnt vmcnt(15) lgkmcnt(7)
    v_mfma_f32_32x32x16_bf16 v[64:79], v[192:195], v[36:39], v[64:79]
    ds_read_b128 v[36:39], v3 offset:17408
    v_lshlrev_b32 v110, 16, v31
    v_and_b32 v111, s66, v31
    s_waitcnt vmcnt(14) lgkmcnt(7)
    v_mfma_f32_32x32x16_bf16 v[64:79], v[196:199], v[40:43], v[64:79]
    ds_read_b128 v[40:43], v3 offset:18432
    s_waitcnt vmcnt(13) lgkmcnt(7)
    v_mfma_f32_32x32x16_bf16 v[64:79], v[200:203], v[44:47], v[64:79]
    ds_read_b128 v[44:47], v3 offset:19456
    s_waitcnt vmcnt(12) lgkmcnt(7)
    v_mfma_f32_32x32x16_bf16 v[64:79], v[204:207], v[48:51], v[64:79]
    ds_read_b128 v[48:51], v3 offset:20480
    s_waitcnt vmcnt(11) lgkmcnt(7)
    v_mfma_f32_32x32x16_bf16 v[64:79], v[208:211], v[52:55], v[64:79]
    ds_read_b128 v[52:55], v3 offset:21504
    s_waitcnt vmcnt(10) lgkmcnt(7)
    v_mfma_f32_32x32x16_bf16 v[64:79], v[212:215], v[56:59], v[64:79]
    ds_read_b128 v[56:59], v3 offset:22528
    s_waitcnt vmcnt(9) lgkmcnt(7)
    v_mfma_f32_32x32x16_bf16 v[64:79], v[216:219], v[60:63], v[64:79]
    ds_read_b128 v[60:63], v3 offset:23552
    s_waitcnt vmcnt(8) lgkmcnt(7)
    v_mfma_f32_32x32x16_bf16 v[64:79], v[220:223], v[32:35], v[64:79]
    ds_read_b128 v[32:35], v3 offset:24576
    s_waitcnt vmcnt(7) lgkmcnt(7)
    v_mfma_f32_32x32x16_bf16 v[64:79], v[224:227], v[36:39], v[64:79]
    s_waitcnt vmcnt(6) lgkmcnt(6)
    v_mfma_f32_32x32x16_bf16 v[64:79], v[228:231], v[40:43], v[64:79]
    s_waitcnt vmcnt(5) lgkmcnt(5)
    v_mfma_f32_32x32x16_bf16 v[64:79], v[232:235], v[44:47], v[64:79]
    s_waitcnt vmcnt(4) lgkmcnt(4)
    v_mfma_f32_32x32x16_bf16 v[64:79], v[236:239], v[48:51], v[64:79]
    s_waitcnt vmcnt(3) lgkmcnt(3)
    v_mfma_f32_32x32x16_bf16 v[64:79], v[240:243], v[52:55], v[64:79]
    s_waitcnt vmcnt(2) lgkmcnt(2)
    v_mfma_f32_32x32x16_bf16 v[64:79], v[244:247], v[56:59], v[64:79]
    s_waitcnt vmcnt(1) lgkmcnt(1)
    v_mfma_f32_32x32x16_bf16 v[64:79], v[248:251], v[60:63], v[64:79]
    s_waitcnt vmcnt(0) lgkmcnt(0)
    v_mfma_f32_32x32x16_bf16 v[64:79], v[252:255], v[32:35], v[64:79]
    s_barrier
    ds_read_b128 v[32:35], v5 offset:0
    ds_read_b128 v[36:39], v5 offset:1024
    ds_read_b128 v[40:43], v5 offset:2048
    ds_read_b128 v[44:47], v5 offset:3072
    ds_read_b64_tr_b16 v[112:113], v17 offset:0
    ds_read_b64_tr_b16 v[114:115], v17 offset:512
    ds_read_b64_tr_b16 v[116:117], v17 offset:1024
    ds_read_b64_tr_b16 v[118:119], v17 offset:1536
    s_waitcnt lgkmcnt(4)
    s_nop 1
    v_pk_add_f32 v[64:65], v[64:65], v[32:33]
    v_pk_add_f32 v[66:67], v[66:67], v[34:35]
    v_pk_add_f32 v[68:69], v[68:69], v[36:37]
    v_pk_add_f32 v[70:71], v[70:71], v[38:39]
    v_pk_add_f32 v[72:73], v[72:73], v[40:41]
    v_pk_add_f32 v[74:75], v[74:75], v[42:43]
    v_pk_add_f32 v[76:77], v[76:77], v[44:45]
    v_pk_add_f32 v[78:79], v[78:79], v[46:47]
    s_waitcnt lgkmcnt(0)
    v_lshlrev_b32 v120, 16, v112
    v_and_b32 v121, s66, v112
    v_lshlrev_b32 v122, 16, v113
    v_and_b32 v123, s66, v113
    v_lshlrev_b32 v124, 16, v114
    v_and_b32 v125, s66, v114
    v_lshlrev_b32 v126, 16, v115
    v_and_b32 v127, s66, v115
    v_lshlrev_b32 v128, 16, v116
    v_and_b32 v129, s66, v116
    v_lshlrev_b32 v130, 16, v117
    v_and_b32 v131, s66, v117
    v_lshlrev_b32 v132, 16, v118
    v_and_b32 v133, s66, v118
    v_lshlrev_b32 v134, 16, v119
    v_and_b32 v135, s66, v119
    v_pk_mul_f32 v[96:97], v[96:97], v[120:121]
    v_pk_mul_f32 v[98:99], v[98:99], v[122:123]
    v_pk_mul_f32 v[100:101], v[100:101], v[124:125]
    v_pk_mul_f32 v[102:103], v[102:103], v[126:127]
    v_pk_mul_f32 v[104:105], v[104:105], v[128:129]
    v_pk_mul_f32 v[106:107], v[106:107], v[130:131]
    v_pk_mul_f32 v[108:109], v[108:109], v[132:133]
    v_pk_mul_f32 v[110:111], v[110:111], v[134:135]
    v_pk_add_f32 v[64:65], v[64:65], v[96:97] neg_lo:[0,1] neg_hi:[0,1]
    v_pk_add_f32 v[66:67], v[66:67], v[98:99] neg_lo:[0,1] neg_hi:[0,1]
    v_pk_add_f32 v[68:69], v[68:69], v[100:101] neg_lo:[0,1] neg_hi:[0,1]
    v_pk_add_f32 v[70:71], v[70:71], v[102:103] neg_lo:[0,1] neg_hi:[0,1]
    v_pk_add_f32 v[72:73], v[72:73], v[104:105] neg_lo:[0,1] neg_hi:[0,1]
    v_pk_add_f32 v[74:75], v[74:75], v[106:107] neg_lo:[0,1] neg_hi:[0,1]
    v_pk_add_f32 v[76:77], v[76:77], v[108:109] neg_lo:[0,1] neg_hi:[0,1]
    v_pk_add_f32 v[78:79], v[78:79], v[110:111] neg_lo:[0,1] neg_hi:[0,1]
    v_pk_fma_f32 v[64:65], v[64:65], v[24:25], v[96:97] op_sel_hi:[1,0,1]
    v_pk_fma_f32 v[66:67], v[66:67], v[24:25], v[98:99] op_sel_hi:[1,0,1]
    v_pk_fma_f32 v[68:69], v[68:69], v[24:25], v[100:101] op_sel_hi:[1,0,1]
    v_pk_fma_f32 v[70:71], v[70:71], v[24:25], v[102:103] op_sel_hi:[1,0,1]
    v_pk_fma_f32 v[72:73], v[72:73], v[24:25], v[104:105] op_sel_hi:[1,0,1]
    v_pk_fma_f32 v[74:75], v[74:75], v[24:25], v[106:107] op_sel_hi:[1,0,1]
    v_pk_fma_f32 v[76:77], v[76:77], v[24:25], v[108:109] op_sel_hi:[1,0,1]
    v_pk_fma_f32 v[78:79], v[78:79], v[24:25], v[110:111] op_sel_hi:[1,0,1]
    v_cvt_pk_bf16_f32 v112, v64, v65
    v_cvt_pk_bf16_f32 v113, v66, v67
    v_cvt_pk_bf16_f32 v114, v68, v69
    v_cvt_pk_bf16_f32 v115, v70, v71
    v_cvt_pk_bf16_f32 v116, v72, v73
    v_cvt_pk_bf16_f32 v117, v74, v75
    v_cvt_pk_bf16_f32 v118, v76, v77
    v_cvt_pk_bf16_f32 v119, v78, v79
    v_permlane32_swap_b32 v112, v114
    v_permlane32_swap_b32 v113, v115
    buffer_store_dwordx4 v[112:115], v14, s[36:39], s96 offen offset:0
    v_permlane32_swap_b32 v116, v118
    v_permlane32_swap_b32 v117, v119
    buffer_store_dwordx4 v[116:119], v14, s[36:39], s96 offen offset:32
Lfin:
Lend:
    s_endpgm
.section .rodata,"a"
.p2align 6
.amdhsa_kernel gated_mix__linear_attn_block__ssm_conv_h3__prompt_kernel
  .amdhsa_next_free_vgpr 256
  .amdhsa_next_free_sgpr 102
  .amdhsa_accum_offset 256
  .amdhsa_group_segment_fixed_size 0
  .amdhsa_kernarg_size 104
  .amdhsa_user_sgpr_count 2
  .amdhsa_user_sgpr_kernarg_segment_ptr 1
  .amdhsa_system_sgpr_workgroup_id_x 1
.end_amdhsa_kernel
```
